```python
import torch

def _softmax(x, axis=-1):
    return torch.softmax(x, dim=axis)
def _gelu(x):
    return torch.nn.functional.gelu(x, approximate="tanh")
def _silu(x):
    return torch.nn.functional.silu(x)
def _sigmoid(x):
    return torch.sigmoid(x)
def _layernorm(x, axis=-1, eps=1e-5):
    m = x.mean(dim=axis, keepdim=True)
    v = x.var(dim=axis, keepdim=True, unbiased=False)
    return (x - m) / torch.sqrt(v + eps)
def _scatter_add(tgt, idx, src, axis=0):
    return tgt.clone().index_add_(axis, idx, src)
def _segment_sum(src, seg, n):
    out = torch.zeros((n,) + src.shape[1:], dtype=src.dtype)
    return out.index_add_(0, seg, src)
def _pad(x, pw):
    flat = tuple(v for pair in reversed(pw) for v in pair)
    return torch.nn.functional.pad(x, flat)

kernel_name = 'recurrent_scan__ssm_conv_h3__dense_activation_mish__prompt'

def setup_inputs():

    _w = (lambda a: (lambda t: t.to(torch.bfloat16) if t.is_floating_point() else t)(torch.as_tensor(a)))
    def _A_setup():
        B, S, D = 1, 2048, 512
        ks = 4
        return {
            "q": _w((lambda *s: torch.randn(*s, dtype=torch.bfloat16) * 0.05)(B, S, D)),
            "k": _w((lambda *s: torch.randn(*s, dtype=torch.bfloat16) * 0.8)(B, S, D)),
            "v": _w((lambda *s: torch.randn(*s, dtype=torch.bfloat16) * 0.8)(B, S, D)),
            "shift_k": _w((lambda *s: torch.randn(*s, dtype=torch.bfloat16) * 0.8)(D, ks) * 0.5),
            "ssm_k": _w((lambda *s: torch.randn(*s, dtype=torch.bfloat16) * 0.8)(D, S) * (1.0 / S ** 0.5)),
            "ssm_D": _w((lambda *s: torch.randn(*s, dtype=torch.bfloat16) * 0.8)(D)),
        }
    _A_in = _A_setup()

    def _B_setup():
        B, S, D, F = 1, 2048, 512, 1792
        return {
            "x": _w((lambda *s: torch.randn(*s, dtype=torch.bfloat16) * 0.05)(B, S, D)),
            "w1": _w((lambda *s: torch.randn(*s, dtype=torch.bfloat16) * 0.8)(D, F) * (D ** -0.5)),
            "b1": _w((lambda *s: torch.randn(*s, dtype=torch.bfloat16) * 0.2)(F)),
            "w2": _w((lambda *s: torch.randn(*s, dtype=torch.bfloat16) * 0.2)(F, D) * (F ** -0.5)),
        }
    _B_in = _B_setup()

    return {
        "A_q": _A_in["q"],
        "A_k": _A_in["k"],
        "A_v": _A_in["v"],
        "A_shift_k": _A_in["shift_k"],
        "A_ssm_k": _A_in["ssm_k"],
        "A_ssm_D": _A_in["ssm_D"],
        "B_x": _B_in["x"],
        "B_w1": _B_in["w1"],
        "B_b1": _B_in["b1"],
        "B_w2": _B_in["w2"],
    }

def reference(A_q, A_k, A_v, A_shift_k, A_ssm_k, A_ssm_D, B_x, B_w1, B_b1, B_w2):
    def _A_ref(q, k, v, shift_k, ssm_k, ssm_D):
        B, S, D = q.shape
        ks = shift_k.shape[-1]
        k_pad = _pad(k, ((0, 0), (ks - 1, 0), (0, 0)))
        k_shift = torch.zeros_like(k)
        for t in range(ks):
            k_shift = k_shift + k_pad[:, t:t + S, :] * shift_k[:, ks - 1 - t][None, None, :]
        kv = k_shift * v
        L = 2 * S
        kv_pad = _pad(kv, ((0, 0), (0, S), (0, 0)))
        kf_pad = _pad(ssm_k, ((0, 0), (0, S)))
        kv_f = (lambda x, axes=(-2,-1): torch.fft.rfft2(x.float(), dim=axes))(kv_pad[:, None, :, :], axes=(1, 2))
        kf_f = (lambda x, axes=(-2,-1): torch.fft.rfft2(x.float(), dim=axes))(kf_pad[:, None, :], axes=(1, 2))
        kf_f = (lambda x, *d: x.permute(*d))(kf_f, 1, 2, 0)
        y_f = kv_f * kf_f[None, :, :, :]
        y = (lambda x, s, axes=(-2,-1): torch.fft.irfft2(x, s=s, dim=axes).to(torch.bfloat16))(y_f, (1, L), axes=(1, 2))[:, 0, :S, :]
        y = y + kv * ssm_D[None, None, :]
        return q * y

    def _B_ref(x, w1, b1, w2):
        h = torch.einsum("bsd,df->bsf", x, w1) + b1
        sp = torch.log1p(torch.exp(-torch.abs(h))) + torch.where(h > 0, h, torch.zeros_like(h))
        act = h * torch.tanh(sp)
        return torch.einsum("bsf,fd->bsd", act, w2)

    x = A_q
    xn = _layernorm(x, axis=-1)
    s = _A_ref(xn, A_k, A_v, A_shift_k, A_ssm_k, A_ssm_D)
    g = _silu(_B_ref(xn, B_w1, B_b1, B_w2))
    return x + s * g
```

```asm
; @launch grid=(256,1,1) block=(512,1,1) lds=161536
.amdgcn_target "amdgcn-amd-amdhsa--gfx950"
.text
.set CODE_BYTES, L_code_end - L_code_base
.set CODE_NL, (CODE_BYTES + 32*128 - 1) / (32*128)
.globl recurrent_scan__ssm_conv_h3__dense_activation_mish__prompt_kernel
.p2align 8
.type recurrent_scan__ssm_conv_h3__dense_activation_mish__prompt_kernel,@function
recurrent_scan__ssm_conv_h3__dense_activation_mish__prompt_kernel:
    s_cmp_ge_u32 s2, 256
    s_cbranch_scc1 L_all_end

    v_lshrrev_b32 v2, 6, v0
    s_getpc_b64 s[60:61]
L_code_base:
    v_cmp_eq_u32 vcc, 7, v2
    s_lshr_b32 s52, s2, 3
    s_mul_i32 s52, s52, CODE_NL
    v_and_b32 v1, 63, v0
    v_add_u32 v3, s52, v1
    v_lshlrev_b32 v3, 7, v3
    s_and_saveexec_b64 s[54:55], vcc
    s_cbranch_execz L_cp_skip_1
    v_cmp_gt_u32 vcc, CODE_NL, v1
    s_and_b64 exec, exec, vcc
    v_cmp_gt_u32 vcc, CODE_BYTES, v3
    s_and_b64 exec, exec, vcc
    s_cbranch_execz L_cp_skip_1
    global_load_dword v193, v3, s[60:61]

L_cp_skip_1:
    s_mov_b64 exec, -1
    s_load_dwordx4 s[4:7], s[0:1], 0
    s_load_dwordx4 s[8:11], s[0:1], 16
    s_load_dwordx4 s[12:15], s[0:1], 56
    s_load_dwordx4 s[48:51], s[0:1], 88
    v_and_b32 v1, 63, v0
    v_lshrrev_b32 v2, 6, v0
    s_nop 0
    v_readfirstlane_b32 s18, v2
    s_lshl_b32 s52, s2, 3
    v_lshrrev_b32 v3, 3, v1
    v_add_u32 v3, s52, v3
    v_lshlrev_b32 v3, 10, v3
    v_and_b32 v4, 7, v1
    v_lshl_add_u32 v190, v4, 4, v3
    s_waitcnt lgkmcnt(0)

    s_mov_b32 s20, s4
    s_mov_b32 s21, s5
    s_mov_b32 s22, 2097152
    s_mov_b32 s23, 0x00020000
    s_mov_b32 s24, s12
    s_mov_b32 s25, s13
    s_mov_b32 s26, 1835008
    s_mov_b32 s27, 0x00020000
    s_cmp_ge_u32 s2, 32
    s_cbranch_scc1 L_fr_gemm_2
    s_mov_b32 s3, s2
    v_mov_b32 v2, 161284
    v_mov_b32 v3, 0
    ds_write_b32 v2, v3
    ds_write_b32 v2, v3 offset:4
    ds_write_b32 v2, v3 offset:8

    s_cmp_lt_u32 s3, 28
    s_cselect_b32 s63, s26, 0
    v_lshrrev_b32 v3, 3, v1
    v_and_b32 v4, 7, v1
    s_lshl_b32 s60, s18, 6
    v_add_u32 v7, s60, v3
    v_mul_u32_u24 v7, 3584, v7
    v_bfe_u32 v2, v1, 4, 1
    v_lshlrev_b32 v2, 2, v2
    v_xor_b32 v2, v2, v4
    v_lshl_add_u32 v7, v2, 4, v7
    s_lshl_b32 s60, s3, 7
    s_lshl_b32 s61, s18, 13
    s_mov_b32 s36, s24
    s_mov_b32 s37, s25
    s_mov_b32 s38, s63
    s_mov_b32 s39, 0x00020000

    s_add_u32 m0, s61, 0
    s_add_u32 s32, s60, 0
    buffer_load_dwordx4 v7, s[36:39], s32 offen lds
    s_add_u32 m0, s61, 1024
    s_add_u32 s32, s60, 28672
    buffer_load_dwordx4 v7, s[36:39], s32 offen lds
    s_add_u32 m0, s61, 2048
    s_add_u32 s32, s60, 57344
    buffer_load_dwordx4 v7, s[36:39], s32 offen lds
    s_add_u32 m0, s61, 3072
    s_add_u32 s32, s60, 86016
    buffer_load_dwordx4 v7, s[36:39], s32 offen lds
    s_add_u32 m0, s61, 4096
    s_add_u32 s32, s60, 114688
    buffer_load_dwordx4 v7, s[36:39], s32 offen lds
    s_add_u32 m0, s61, 5120
    s_add_u32 s32, s60, 143360
    buffer_load_dwordx4 v7, s[36:39], s32 offen lds
    s_add_u32 m0, s61, 6144
    s_add_u32 s32, s60, 172032
    buffer_load_dwordx4 v7, s[36:39], s32 offen lds
    s_add_u32 m0, s61, 7168
    s_add_u32 s32, s60, 200704
    buffer_load_dwordx4 v7, s[36:39], s32 offen lds
    s_cmp_lg_u32 s18, 4
    s_cbranch_scc1 L_rows_4

    buffer_load_dwordx4 v[64:67], v190, s[20:23], 0 offen offset:0
    buffer_load_dwordx4 v[68:71], v190, s[20:23], 0 offen offset:128
    buffer_load_dwordx4 v[72:75], v190, s[20:23], 0 offen offset:256
    buffer_load_dwordx4 v[76:79], v190, s[20:23], 0 offen offset:384
    buffer_load_dwordx4 v[80:83], v190, s[20:23], 0 offen offset:512
    buffer_load_dwordx4 v[84:87], v190, s[20:23], 0 offen offset:640
    buffer_load_dwordx4 v[88:91], v190, s[20:23], 0 offen offset:768
    buffer_load_dwordx4 v[92:95], v190, s[20:23], 0 offen offset:896
L_rows_4:
    s_lshr_b32 s52, s2, 3
    s_and_b32 s53, s2, 7
    v_lshrrev_b32 v3, 3, v1
    v_and_b32 v4, 7, v1
    s_lshl_b32 s54, s52, 6
    s_lshl_b32 s55, s18, 3
    s_add_u32 s54, s54, s55
    v_add_u32 v5, s54, v3
    v_lshlrev_b32 v5, 10, v5
    v_lshl_add_u32 v5, v4, 4, v5
    s_lshl_b32 s55, s53, 7
    v_add_u32 v5, s55, v5
    v_subrev_u32 v6, 8192, v5
    v_and_b32 v7, 31, v0
    v_lshlrev_b32 v7, 4, v7
    s_lshl_b32 s54, s53, 9
    v_add_u32 v7, s54, v7
    s_mov_b32 s60, s6
    s_mov_b32 s61, s7

    s_mov_b32 s4, s60
    s_mov_b32 s5, s61
    s_mov_b32 s6, 2097152
    s_mov_b32 s7, 0x00020000
    s_lshl_b32 s54, s18, 10
    s_add_u32 m0, s54, 131072
    s_cmp_lg_u32 s18, 7
    buffer_load_dwordx4 v6, s[4:7], 0 offen lds

    s_cbranch_scc1 L_kv_no9_5
    s_mov_b32 m0, 139264
    s_nop 0
    buffer_load_dwordx4 v5, s[4:7], 0 offen lds

L_kv_no9_5:
    s_mov_b32 s4, s8
    s_mov_b32 s5, s9
    s_add_u32 m0, s54, 140288
    s_nop 0
    buffer_load_dwordx4 v5, s[4:7], 0 offen lds
    s_mov_b32 s4, s10
    s_mov_b32 s5, s11
    s_mov_b32 s6, 4096
    buffer_load_dwordx4 v[124:127], v7, s[4:7], 0 offen

    s_mov_b32 s40, s14
    s_mov_b32 s41, s15
    s_mov_b32 s42, 3584
    s_mov_b32 s43, 0x00020000
    s_lshl_b32 s60, s3, 6
    v_add_lshl_u32 v104, v1, s60, 1
    buffer_load_ushort v105, v104, s[40:43], 0 offen

    s_mov_b32 s56, s48
    s_mov_b32 s57, s49
    s_mov_b32 s58, 256
    s_mov_b32 s59, 0x00020000
    s_mov_b32 s28, s50
    s_mov_b32 s29, s51
    s_mov_b32 s30, 268435456
    s_mov_b32 s31, 0x00020000
    s_load_dwordx2 s[48:49], s[0:1], 72
    s_load_dwordx4 s[52:55], s[0:1], 32
    s_load_dwordx2 s[8:9], s[0:1], 80

    s_waitcnt lgkmcnt(0)
    s_mov_b32 s50, s52
    s_mov_b32 s51, s53
    s_bfe_u32 s60, s18, 0x10001
    s_lshl_b32 s61, s2, 1
    s_add_u32 s61, s61, s60
    s_lshl_b32 s61, s61, 12
    s_add_u32 s52, s52, s61
    s_addc_u32 s53, s53, 0
    s_load_dword s16, s[52:53], 0
    s_lshl_b32 s61, s2, 2
    s_add_u32 s54, s54, s61
    s_addc_u32 s55, s55, 0
    s_load_dword s17, s[54:55], 0

    s_lshl_b32 s52, s2, 3
    s_add_u32 s52, s52, s18
    s_cmp_lg_u32 s52, 1
    s_cbranch_scc1 L_nonce_6
    s_memrealtime s[52:53]
    s_waitcnt lgkmcnt(0)
    s_or_b32 s52, s52, 1
    v_mov_b32 v2, s52
    v_mov_b32 v3, 0
    s_mov_b64 exec, 1
    buffer_store_dword v2, v3, s[56:59], 0 offen sc1
    s_mov_b64 exec, -1

L_nonce_6:
    v_mov_b32 v60, 0x3f803f80
    v_bfe_u32 v2, v1, 2, 2
    v_bfe_u32 v3, v1, 4, 1
    v_lshrrev_b32 v5, 5, v1
    v_bfe_u32 v6, v1, 1, 1
    v_lshl_add_u32 v6, v3, 1, v6
    v_lshrrev_b32 v7, 1, v2
    v_lshl_add_u32 v2, v5, 2, v2
    v_lshlrev_b32 v2, 7, v2
    v_and_b32 v3, 1, v1
    v_lshl_add_u32 v2, v3, 3, v2
    s_lshl_b32 s53, s18, 13
    v_add_u32 v2, s53, v2
    v_lshl_add_u32 v3, v7, 2, v6
    v_lshl_add_u32 v8, v3, 4, v2
    v_xor_b32 v3, 4, v3
    v_lshl_add_u32 v9, v3, 4, v2
    v_mov_b32 v61, v60
    v_mov_b32 v62, v60
    v_mov_b32 v63, v60
    s_waitcnt vmcnt(4)

    ds_read_b64_tr_b16 v[10:11], v8 offset:0
    ds_read_b64_tr_b16 v[12:13], v8 offset:1024
    ds_read_b64_tr_b16 v[14:15], v9 offset:0
    ds_read_b64_tr_b16 v[16:17], v9 offset:1024
    ds_read_b64_tr_b16 v[18:19], v8 offset:2048
    ds_read_b64_tr_b16 v[20:21], v8 offset:3072
    ds_read_b64_tr_b16 v[22:23], v9 offset:2048
    ds_read_b64_tr_b16 v[24:25], v9 offset:3072
    s_waitcnt lgkmcnt(4)
    ds_read_b64_tr_b16 v[26:27], v8 offset:4096
    ds_read_b64_tr_b16 v[28:29], v8 offset:5120
    ds_read_b64_tr_b16 v[30:31], v9 offset:4096
    ds_read_b64_tr_b16 v[32:33], v9 offset:5120
    ds_read_b64_tr_b16 v[34:35], v8 offset:6144
    ds_read_b64_tr_b16 v[36:37], v8 offset:7168
    ds_read_b64_tr_b16 v[38:39], v9 offset:6144
    ds_read_b64_tr_b16 v[40:41], v9 offset:7168
    s_waitcnt lgkmcnt(0)
    v_mfma_f32_32x32x16_bf16 v[164:179], v[10:13], v[60:63], 0
    v_mfma_f32_32x32x16_bf16 v[180:195], v[14:17], v[60:63], 0
    v_mfma_f32_32x32x16_bf16 v[164:179], v[18:21], v[60:63], v[164:179]
    v_mfma_f32_32x32x16_bf16 v[180:195], v[22:25], v[60:63], v[180:195]
    v_mfma_f32_32x32x16_bf16 v[164:179], v[26:29], v[60:63], v[164:179]
    v_mfma_f32_32x32x16_bf16 v[180:195], v[30:33], v[60:63], v[180:195]
    v_mfma_f32_32x32x16_bf16 v[164:179], v[34:37], v[60:63], v[164:179]
    v_mfma_f32_32x32x16_bf16 v[180:195], v[38:41], v[60:63], v[180:195]
    s_lshl_b32 s53, s18, 8
    s_add_u32 s53, s53, 159232
    v_lshl_add_u32 v3, v5, 4, s53
    s_mov_b32 s60, 1
    s_mov_b32 s61, 1
    s_nop 7
    s_nop 3
    s_mov_b64 exec, s[60:61]

    ds_write_b128 v3, v[164:167] offset:0
    ds_write_b128 v3, v[168:171] offset:32
    ds_write_b128 v3, v[172:175] offset:64
    ds_write_b128 v3, v[176:179] offset:96
    ds_write_b128 v3, v[180:183] offset:128
    ds_write_b128 v3, v[184:187] offset:160
    ds_write_b128 v3, v[188:191] offset:192
    ds_write_b128 v3, v[192:195] offset:224
    s_mov_b64 exec, -1
    s_waitcnt vmcnt(1) lgkmcnt(0)
    s_barrier

    s_cmp_lt_u32 s18, 4
    s_cbranch_scc1 L_pp_kv_7
    s_cmp_eq_u32 s18, 4
    s_cbranch_scc1 L_pp_st_8
    s_cmp_lg_u32 s18, 5
    s_cbranch_scc1 L_pp_p2_10
    s_waitcnt vmcnt(0)

    v_mov_b32 v2, 0
    buffer_load_dword v151, v2, s[56:59], 0 offen sc1
    v_lshlrev_b32 v2, 2, v1
    v_add_u32 v2, 159232, v2
    ds_read_b32 v8, v2 offset:0
    ds_read_b32 v9, v2 offset:256
    ds_read_b32 v10, v2 offset:512
    ds_read_b32 v11, v2 offset:768
    ds_read_b32 v12, v2 offset:1024
    ds_read_b32 v13, v2 offset:1280
    ds_read_b32 v14, v2 offset:1536
    ds_read_b32 v15, v2 offset:1792
    v_lshlrev_b32 v16, 16, v105
    v_mul_f32 v16, 0x3fb8aa3b, v16
    v_lshlrev_b32 v5, 1, v104
    s_mov_b32 s36, s28
    s_mov_b32 s37, s29
    s_cmp_lt_u32 s3, 28
    s_cselect_b32 s38, s30, 0
    s_mov_b32 s39, 0x00020000
    s_mov_b32 s53, 40960
    buffer_store_dword v16, v5, s[36:39], s53 offen sc1
    s_waitcnt lgkmcnt(0)
    v_add_f32 v8, v8, v9
    v_add_f32 v10, v10, v11
    v_add_f32 v12, v12, v13
    v_add_f32 v14, v14, v15
    v_add_f32 v8, v8, v10
    v_add_f32 v12, v12, v14
    v_add_f32 v8, v8, v12
    s_mov_b32 s53, 32768
    buffer_store_dword v8, v5, s[36:39], s53 offen sc1
    s_waitcnt vmcnt(2)

    s_mov_b32 s54, 0
L_nonce_spin_11:
    v_readfirstlane_b32 s62, v151
    s_add_u32 s54, s54, 1
    s_cmp_lg_u32 s62, 0
    s_cbranch_scc1 L_nonce_done_12
    s_cmp_ge_u32 s54, 0x40000
    s_cbranch_scc1 L_nonce_done_12
    s_sleep 1

    v_mov_b32 v2, 0
    buffer_load_dword v151, v2, s[56:59], 0 offen sc1
    s_waitcnt vmcnt(0)
    s_branch L_nonce_spin_11

L_nonce_done_12:
    v_mov_b32 v2, 161280
    v_mov_b32 v3, s62
    ds_write_b32 v2, v3
    s_waitcnt lgkmcnt(0)

    s_waitcnt vmcnt(0)
    s_lshl_b32 s52, s3, 7
    s_add_u32 s52, s52, 163840

    v_mov_b32 v2, s52
    v_mov_b32 v3, s62
    s_mov_b64 exec, 1
    buffer_store_dword v3, v2, s[28:31], 0 offen sc1
    s_mov_b64 exec, -1

    s_branch L_pp_p2_10
L_pp_kv_7:
    v_and_b32 v2, 31, v1
    v_lshrrev_b32 v3, 5, v1
    s_lshl_b32 s52, s18, 1
    v_add_u32 v3, s52, v3
    v_lshlrev_b32 v4, 10, v3
    v_lshl_add_u32 v4, v2, 2, v4
    v_add_u32 v5, 131712, v4
    v_add_u32 v6, 140288, v4

    ds_read_b32 v40, v5 offset:0
    ds_read_b32 v41, v5 offset:128
    ds_read_b32 v42, v5 offset:256
    ds_read_b32 v43, v5 offset:384
    ds_read_b32 v44, v5 offset:512
    ds_read_b32 v45, v5 offset:640
    ds_read_b32 v46, v5 offset:768
    ds_read_b32 v47, v5 offset:896
    ds_read_b32 v48, v5 offset:1024
    ds_read_b32 v49, v5 offset:1152
    ds_read_b32 v50, v5 offset:1280
    v_lshlrev_b32 v102, 16, v124
    v_lshlrev_b32 v103, 16, v126
    v_and_b32 v104, 0xffff0000, v124
    v_and_b32 v105, 0xffff0000, v126
    v_lshlrev_b32 v106, 16, v125
    v_lshlrev_b32 v107, 16, v127
    v_and_b32 v108, 0xffff0000, v125
    v_and_b32 v109, 0xffff0000, v127
    v_sub_u32 v3, 7, v3
    v_and_b32 v7, 7, v2
    v_xor_b32 v3, v3, v7
    v_lshlrev_b32 v3, 4, v3
    v_lshl_add_u32 v3, v2, 8, v3
    v_add_u32 v3, 148480, v3
    s_waitcnt lgkmcnt(4)

    ds_read_b32 v51, v6 offset:0
    ds_read_b32 v52, v6 offset:128
    ds_read_b32 v53, v6 offset:256
    ds_read_b32 v54, v6 offset:384
    ds_read_b32 v55, v6 offset:512
    ds_read_b32 v56, v6 offset:640
    ds_read_b32 v57, v6 offset:768
    ds_read_b32 v58, v6 offset:896
    v_lshlrev_b32 v64, 16, v40
    v_and_b32 v65, 0xffff0000, v40
    v_lshlrev_b32 v66, 16, v41
    v_and_b32 v67, 0xffff0000, v41
    v_lshlrev_b32 v68, 16, v42
    v_and_b32 v69, 0xffff0000, v42
    v_lshlrev_b32 v70, 16, v43
    v_and_b32 v71, 0xffff0000, v43
    v_lshlrev_b32 v72, 16, v44
    v_and_b32 v73, 0xffff0000, v44
    v_lshlrev_b32 v74, 16, v45
    v_and_b32 v75, 0xffff0000, v45
    v_lshlrev_b32 v76, 16, v46
    v_and_b32 v77, 0xffff0000, v46
    s_waitcnt lgkmcnt(8)
    v_lshlrev_b32 v78, 16, v47
    v_and_b32 v79, 0xffff0000, v47
    v_lshlrev_b32 v80, 16, v48
    v_and_b32 v81, 0xffff0000, v48
    v_lshlrev_b32 v82, 16, v49
    v_and_b32 v83, 0xffff0000, v49
    v_lshlrev_b32 v84, 16, v50
    v_and_b32 v85, 0xffff0000, v50
    v_pk_mul_f32 v[8:9], v[64:65], v[108:109]
    v_pk_mul_f32 v[10:11], v[66:67], v[108:109]
    v_pk_mul_f32 v[12:13], v[68:69], v[108:109]
    v_pk_mul_f32 v[14:15], v[70:71], v[108:109]
    v_pk_mul_f32 v[16:17], v[72:73], v[108:109]
    v_pk_mul_f32 v[18:19], v[74:75], v[108:109]
    v_pk_mul_f32 v[20:21], v[76:77], v[108:109]
    v_pk_mul_f32 v[22:23], v[78:79], v[108:109]
    v_pk_fma_f32 v[8:9], v[66:67], v[106:107], v[8:9]
    v_pk_fma_f32 v[10:11], v[68:69], v[106:107], v[10:11]
    v_pk_fma_f32 v[12:13], v[70:71], v[106:107], v[12:13]
    v_pk_fma_f32 v[14:15], v[72:73], v[106:107], v[14:15]
    v_pk_fma_f32 v[16:17], v[74:75], v[106:107], v[16:17]
    v_pk_fma_f32 v[18:19], v[76:77], v[106:107], v[18:19]
    v_pk_fma_f32 v[20:21], v[78:79], v[106:107], v[20:21]
    v_pk_fma_f32 v[22:23], v[80:81], v[106:107], v[22:23]
    v_pk_fma_f32 v[8:9], v[68:69], v[104:105], v[8:9]
    v_pk_fma_f32 v[10:11], v[70:71], v[104:105], v[10:11]
    v_pk_fma_f32 v[12:13], v[72:73], v[104:105], v[12:13]
    v_pk_fma_f32 v[14:15], v[74:75], v[104:105], v[14:15]
    v_pk_fma_f32 v[16:17], v[76:77], v[104:105], v[16:17]
    v_pk_fma_f32 v[18:19], v[78:79], v[104:105], v[18:19]
    v_pk_fma_f32 v[20:21], v[80:81], v[104:105], v[20:21]
    v_pk_fma_f32 v[22:23], v[82:83], v[104:105], v[22:23]
    v_pk_fma_f32 v[8:9], v[70:71], v[102:103], v[8:9]
    v_pk_fma_f32 v[10:11], v[72:73], v[102:103], v[10:11]
    v_pk_fma_f32 v[12:13], v[74:75], v[102:103], v[12:13]
    v_pk_fma_f32 v[14:15], v[76:77], v[102:103], v[14:15]
    v_pk_fma_f32 v[16:17], v[78:79], v[102:103], v[16:17]
    v_pk_fma_f32 v[18:19], v[80:81], v[102:103], v[18:19]
    v_pk_fma_f32 v[20:21], v[82:83], v[102:103], v[20:21]
    v_pk_fma_f32 v[22:23], v[84:85], v[102:103], v[22:23]
    s_waitcnt lgkmcnt(0)
    v_lshlrev_b32 v86, 16, v51
    v_and_b32 v87, 0xffff0000, v51
    v_lshlrev_b32 v88, 16, v52
    v_and_b32 v89, 0xffff0000, v52
    v_lshlrev_b32 v90, 16, v53
    v_and_b32 v91, 0xffff0000, v53
    v_lshlrev_b32 v92, 16, v54
    v_and_b32 v93, 0xffff0000, v54
    v_lshlrev_b32 v94, 16, v55
    v_and_b32 v95, 0xffff0000, v55
    v_lshlrev_b32 v96, 16, v56
    v_and_b32 v97, 0xffff0000, v56
    v_lshlrev_b32 v98, 16, v57
    v_and_b32 v99, 0xffff0000, v57
    v_lshlrev_b32 v100, 16, v58
    v_and_b32 v101, 0xffff0000, v58
    v_pk_mul_f32 v[8:9], v[8:9], v[86:87]
    v_pk_mul_f32 v[10:11], v[10:11], v[88:89]
    v_pk_mul_f32 v[12:13], v[12:13], v[90:91]
    v_pk_mul_f32 v[14:15], v[14:15], v[92:93]
    v_pk_mul_f32 v[16:17], v[16:17], v[94:95]
    v_pk_mul_f32 v[18:19], v[18:19], v[96:97]
    v_pk_mul_f32 v[20:21], v[20:21], v[98:99]
    v_pk_mul_f32 v[22:23], v[22:23], v[100:101]
    v_cvt_pk_bf16_f32 v24, v22, v20
    v_cvt_pk_bf16_f32 v25, v18, v16
    v_cvt_pk_bf16_f32 v26, v14, v12
    v_cvt_pk_bf16_f32 v27, v10, v8
    ds_write_b128 v3, v[24:27] offset:0
    v_cvt_pk_bf16_f32 v28, v23, v21
    v_cvt_pk_bf16_f32 v29, v19, v17
    v_cvt_pk_bf16_f32 v30, v15, v13
    v_cvt_pk_bf16_f32 v31, v11, v9
    ds_write_b128 v3, v[28:31] offset:128
    s_branch L_pp_p2_10
L_pp_st_8:
    v_mov_b32 v104, 0x3f803f80
    s_nop 0
    v_dot2_f32_bf16 v96, v64, v104, 0
    v_dot2_f32_bf16 v100, v64, v64, 0
    v_dot2_f32_bf16 v97, v65, v104, 0
    v_dot2_f32_bf16 v101, v65, v65, 0
    v_dot2_f32_bf16 v98, v66, v104, 0
    v_dot2_f32_bf16 v102, v66, v66, 0
    v_dot2_f32_bf16 v99, v67, v104, 0
    v_dot2_f32_bf16 v103, v67, v67, 0
    v_dot2_f32_bf16 v96, v68, v104, v96
    v_dot2_f32_bf16 v100, v68, v68, v100
    v_dot2_f32_bf16 v97, v69, v104, v97
    v_dot2_f32_bf16 v101, v69, v69, v101
    v_dot2_f32_bf16 v98, v70, v104, v98
    v_dot2_f32_bf16 v102, v70, v70, v102
    v_dot2_f32_bf16 v99, v71, v104, v99
    v_dot2_f32_bf16 v103, v71, v71, v103
    v_dot2_f32_bf16 v96, v72, v104, v96
    v_dot2_f32_bf16 v100, v72, v72, v100
    v_dot2_f32_bf16 v97, v73, v104, v97
    v_dot2_f32_bf16 v101, v73, v73, v101
    v_dot2_f32_bf16 v98, v74, v104, v98
    v_dot2_f32_bf16 v102, v74, v74, v102
    v_dot2_f32_bf16 v99, v75, v104, v99
    v_dot2_f32_bf16 v103, v75, v75, v103
    v_dot2_f32_bf16 v96, v76, v104, v96
    v_dot2_f32_bf16 v100, v76, v76, v100
    v_dot2_f32_bf16 v97, v77, v104, v97
    v_dot2_f32_bf16 v101, v77, v77, v101
    v_dot2_f32_bf16 v98, v78, v104, v98
    v_dot2_f32_bf16 v102, v78, v78, v102
    v_dot2_f32_bf16 v99, v79, v104, v99
    v_dot2_f32_bf16 v103, v79, v79, v103
    v_dot2_f32_bf16 v96, v80, v104, v96
    v_dot2_f32_bf16 v100, v80, v80, v100
    v_dot2_f32_bf16 v97, v81, v104, v97
    v_dot2_f32_bf16 v101, v81, v81, v101
    v_dot2_f32_bf16 v98, v82, v104, v98
    v_dot2_f32_bf16 v102, v82, v82, v102
    v_dot2_f32_bf16 v99, v83, v104, v99
    v_dot2_f32_bf16 v103, v83, v83, v103
    v_dot2_f32_bf16 v96, v84, v104, v96
    v_dot2_f32_bf16 v100, v84, v84, v100
    v_dot2_f32_bf16 v97, v85, v104, v97
    v_dot2_f32_bf16 v101, v85, v85, v101
    v_dot2_f32_bf16 v98, v86, v104, v98
    v_dot2_f32_bf16 v102, v86, v86, v102
    v_dot2_f32_bf16 v99, v87, v104, v99
    v_dot2_f32_bf16 v103, v87, v87, v103
    v_dot2_f32_bf16 v96, v88, v104, v96
    v_dot2_f32_bf16 v100, v88, v88, v100
    v_dot2_f32_bf16 v97, v89, v104, v97
    v_dot2_f32_bf16 v101, v89, v89, v101
    v_dot2_f32_bf16 v98, v90, v104, v98
    v_dot2_f32_bf16 v102, v90, v90, v102
    v_dot2_f32_bf16 v99, v91, v104, v99
    v_dot2_f32_bf16 v103, v91, v91, v103
    v_dot2_f32_bf16 v96, v92, v104, v96
    v_dot2_f32_bf16 v100, v92, v92, v100
    v_dot2_f32_bf16 v97, v93, v104, v97
    v_dot2_f32_bf16 v101, v93, v93, v101
    v_dot2_f32_bf16 v98, v94, v104, v98
    v_dot2_f32_bf16 v102, v94, v94, v102
    v_dot2_f32_bf16 v99, v95, v104, v99
    v_dot2_f32_bf16 v103, v95, v95, v103
    s_nop 2
    v_add_f32 v96, v96, v97
    v_add_f32 v98, v98, v99
    v_add_f32 v100, v100, v101
    v_add_f32 v102, v102, v103
    v_add_f32 v96, v96, v98
    v_add_f32 v100, v100, v102

    s_nop 1
    v_add_f32_dpp v96, v96, v96 quad_perm:[1,0,3,2] row_mask:0xf bank_mask:0xf
    v_add_f32_dpp v100, v100, v100 quad_perm:[1,0,3,2] row_mask:0xf bank_mask:0xf
    s_nop 1
    v_add_f32_dpp v96, v96, v96 quad_perm:[2,3,0,1] row_mask:0xf bank_mask:0xf
    v_add_f32_dpp v100, v100, v100 quad_perm:[2,3,0,1] row_mask:0xf bank_mask:0xf
    s_nop 1
    v_add_f32_dpp v96, v96, v96 row_half_mirror row_mask:0xf bank_mask:0xf
    v_add_f32_dpp v100, v100, v100 row_half_mirror row_mask:0xf bank_mask:0xf
    v_mul_f32 v97, 0x3b000000, v96
    v_mul_f32 v100, 0x3b000000, v100
    v_fma_f32 v100, -v97, v97, v100
    v_max_f32 v100, 0, v100

    v_cvt_pk_bf16_f32 v100, v100, v100
    v_and_b32 v100, 0xffff0000, v100
    v_add_f32 v100, 0x3727c5ac, v100
    v_cvt_pk_bf16_f32 v100, v100, v100
    v_and_b32 v100, 0xffff0000, v100
    v_sqrt_f32 v100, v100
    s_nop 0
    v_cvt_pk_bf16_f32 v100, v100, v100
    v_and_b32 v100, 0xffff0000, v100
    v_rcp_f32 v99, v100
    v_cvt_pk_bf16_f32 v98, v97, v97
    v_and_b32 v98, 0xffff0000, v98
    v_lshrrev_b32 v3, 3, v1
    s_lshl_b32 s52, s2, 3
    v_add_lshl_u32 v3, v3, s52, 3
    v_and_b32 v4, 7, v1
    v_cmp_eq_u32 vcc, 0, v4
    s_and_saveexec_b64 s[60:61], vcc
    buffer_store_dwordx2 v[98:99], v3, s[28:31], 0 offen offset:0 sc1
    s_mov_b64 exec, s[60:61]

L_pp_p2_10:
    v_lshrrev_b32 v122, 3, v1
    s_lshl_b32 s38, s18, 3
    v_add_u32 v122, s38, v122
    v_lshrrev_b32 v152, 1, v122
    v_and_b32 v152, 7, v152
    v_and_b32 v155, 7, v1
    v_xor_b32 v152, v152, v155
    v_lshlrev_b32 v152, 4, v152
    v_lshl_add_u32 v152, v122, 7, v152
    v_add_u32 v152, 148480, v152
    s_and_b32 s38, s2, 7
    s_lshl_b32 s38, s38, 6
    v_add_u32 v122, s38, v122
    v_lshlrev_b32 v122, 12, v122
    v_lshl_add_u32 v122, v155, 4, v122
    s_waitcnt lgkmcnt(0)
    s_barrier
    ds_read_b128 v[64:67], v152
    v_mov_b32 v2, 161280
    ds_read_b32 v2, v2
    s_lshr_b32 s52, s2, 3
    s_lshl_b32 s52, s52, 7
    s_sub_u32 s52, 1052544, s52
    s_waitcnt lgkmcnt(0)
    buffer_store_dwordx4 v[64:67], v122, s[28:31], s52 offen sc1
    v_readfirstlane_b32 s62, v2
    s_waitcnt vmcnt(0)
    s_barrier

    s_cmp_lg_u32 s18, 5
    s_cbranch_scc1 L_pp_noflags_13

    s_lshl_b32 s52, s2, 7
    s_add_u32 s52, s52, 131072

    v_mov_b32 v2, s52
    v_mov_b32 v3, s62
    s_mov_b64 exec, 1
    buffer_store_dword v3, v2, s[28:31], 0 offen sc1
    s_mov_b64 exec, -1

    s_and_b32 s52, s2, 7
    s_lshl_b32 s52, s52, 12
    s_lshr_b32 s53, s2, 3
    s_lshl_b32 s53, s53, 7
    s_add_u32 s52, s52, s53
    s_add_u32 s52, s52, 196608

    v_mov_b32 v2, s52
    v_mov_b32 v3, s62
    s_mov_b64 exec, 1
    buffer_store_dword v3, v2, s[28:31], 0 offen sc1
    s_mov_b64 exec, -1

L_pp_noflags_13:
    s_mov_b32 s44, s50
    s_mov_b32 s45, s51
    s_mov_b32 s46, 2097152
    s_mov_b32 s47, 0x00020000
    s_lshr_b32 s52, s18, 2
    s_bfe_u32 s53, s18, 0x10001
    s_and_b32 s54, s18, 1
    s_lshl_b32 s54, s54, 11
    s_lshl_b32 s55, s53, 1
    v_lshl_add_u32 v2, v1, 4, s55
    s_mul_i32 s53, s53, 4160
    s_mul_i32 s55, s52, 12928
    s_add_u32 s53, s53, s55
    s_add_u32 s53, s53, s54
    s_add_u32 m0, s53, 131104
    s_lshl_b32 s53, s2, 1
    s_add_u32 s53, s53, s52
    s_lshl_b32 s53, s53, 12
    s_add_u32 s53, s53, s54
    buffer_load_dwordx4 v2, s[44:47], s53 offen lds
    buffer_load_dwordx4 v2, s[44:47], s53 offen offset:1024 lds

    s_cmp_ge_u32 s18, 4
    s_cbranch_scc1 L_pp_nopad_14

    s_lshr_b32 s52, s18, 1
    s_and_b32 s53, s18, 1
    s_mul_i32 s54, s52, 12928
    s_add_u32 s54, s54, 131072
    v_lshl_add_u32 v3, v1, 4, s54
    v_mov_b32 v4, 0
    v_mov_b32 v5, 0
    v_mov_b32 v6, 0
    v_mov_b32 v7, 0
    s_cmp_eq_u32 s53, 1
    s_cbranch_scc1 L_cv_odd_15
    s_mov_b64 exec, 3
    ds_write_b128 v3, v[4:7]
    s_mov_b64 exec, 0x3fffffff
    ds_write_b128 v3, v[4:7] offset:12416
    s_mov_b64 exec, -1
    s_branch L_cv_pad_16

L_cv_odd_15:
    s_lshl_b32 s52, s16, 16
    v_cmp_eq_u32 vcc, 1, v1
    v_mov_b32 v7, s52
    s_nop 0
    v_cndmask_b32 v7, 0, v7, vcc
    s_mov_b64 exec, 3
    ds_write_b128 v3, v[4:7] offset:4160
    s_mov_b64 exec, -1

L_cv_pad_16:
L_pp_nopad_14:
    s_mov_b32 s4, s50
    s_mov_b32 s5, s51
    s_mov_b32 s6, 2097152
    s_mov_b32 s7, 0x00020000
    s_lshl_b32 s52, s2, 3
    s_add_u32 s52, s52, s18
    s_lshl_b32 s52, s52, 13
    v_lshl_add_u32 v2, v1, 7, s52
    buffer_load_dword v192, v2, s[4:7], 0 offen
    s_cmp_eq_u32 s18, 0
    s_cbranch_scc1 L_wt_w0_17
    s_mov_b32 s4, s48
    s_mov_b32 s5, s49
    s_mov_b32 s6, 1835008
    s_mul_i32 s52, s2, 7
    s_add_u32 s52, s52, s18
    s_sub_u32 s52, s52, 1
    s_lshl_b32 s52, s52, 13
    v_lshl_add_u32 v2, v1, 7, s52
    buffer_load_dword v193, v2, s[4:7], 0 offen

L_wt_w0_17:
    s_cmp_lg_u32 s18, 0
    s_cbranch_scc1 L_pp_nou_18

    s_lshr_b32 s52, s2, 5
    s_lshl_b32 s52, s52, 12
    s_add_u32 s52, s52, 196608
    v_and_b32 v3, 31, v1
    v_lshl_add_u32 v2, v3, 7, s52

    s_mov_b32 s63, 0
L_pp_kvf_spin_19:
    buffer_load_dword v3, v2, s[28:31], 0 offen sc1
    s_add_u32 s63, s63, 1
    s_waitcnt vmcnt(0)
    v_cmp_ne_u32 vcc, s62, v3
    s_nop 1
    s_cmp_eq_u64 vcc, 0
    s_cbranch_scc1 L_pp_kvf_done_20
    s_cmp_ge_u32 s63, 0x40000
    s_cbranch_scc1 L_pp_kvf_done_20
    s_sleep 4
    s_branch L_pp_kvf_spin_19

L_pp_kvf_done_20:
    s_lshl_b32 s52, s2, 13
    s_add_u32 s52, s52, 1048576
    v_lshlrev_b32 v2, 4, v1

    s_mov_b32 m0, 139392
    s_add_u32 s53, s52, 0
    buffer_load_dwordx4 v2, s[28:31], s53 offen offset:0 sc1 lds
    buffer_load_dwordx4 v2, s[28:31], s53 offen offset:1024 sc1 lds
    buffer_load_dwordx4 v2, s[28:31], s53 offen offset:2048 sc1 lds
    buffer_load_dwordx4 v2, s[28:31], s53 offen offset:3072 sc1 lds
    s_mov_b32 m0, 152320
    s_add_u32 s53, s52, 4096
    buffer_load_dwordx4 v2, s[28:31], s53 offen offset:0 sc1 lds
    buffer_load_dwordx4 v2, s[28:31], s53 offen offset:1024 sc1 lds
    buffer_load_dwordx4 v2, s[28:31], s53 offen offset:2048 sc1 lds
    buffer_load_dwordx4 v2, s[28:31], s53 offen offset:3072 sc1 lds
L_pp_nou_18:
    s_waitcnt vmcnt(0) lgkmcnt(0)
    s_barrier

    s_mov_b32 s19, -1
    s_mov_b32 s24, s48
    s_mov_b32 s25, s49
    s_mov_b32 s26, 1835008
    s_mov_b32 s27, 0x00020000
    v_lshrrev_b32 v183, 3, v1
    v_lshlrev_b32 v183, 10, v183
    v_bfe_u32 v184, v1, 4, 1
    v_lshlrev_b32 v184, 2, v184
    v_xor_b32 v184, v184, v1
    v_and_b32 v184, 7, v184
    v_lshl_add_u32 v183, v184, 4, v183
    s_lshl_b32 s60, s18, 14
    s_lshr_b32 s61, s2, 3
    s_and_b32 s61, s61, 7
    s_lshl_b32 s61, s61, 7
    s_add_u32 s60, s60, s61
    s_lshl_b32 s61, s18, 11
    s_add_u32 s61, s61, 16384

    s_and_b32 s52, s2, 7
    s_lshr_b32 s53, s2, 3
    s_lshr_b32 s35, s53, 3
    s_lshl_b32 s52, s52, 2
    s_add_u32 s35, s35, s52
    s_and_b32 s34, s53, 7

    s_lshl_b32 s43, s34, 1
    s_and_b32 s52, s35, 3
    s_mul_i32 s52, s52, 3
    s_add_u32 s43, s43, s52
    s_cmp_ge_u32 s43, 14
    s_cselect_b32 s52, 14, 0
    s_sub_u32 s43, s43, s52

    s_add_u32 s54, s43, 0
    s_cmp_ge_u32 s54, 14
    s_cselect_b32 s55, 14, 0
    s_sub_u32 s54, s54, s55
    s_lshl_b32 s54, s54, 17
    s_add_u32 s54, s54, s60
    s_add_u32 s55, s54, 7168
    s_add_u32 m0, s61, 0
    s_nop 0
    buffer_load_dwordx4 v183, s[24:27], s54 offen lds
    buffer_load_dwordx4 v183, s[24:27], s55 offen offset:1024 lds

    s_add_u32 s54, s43, 1
    s_cmp_ge_u32 s54, 14
    s_cselect_b32 s55, 14, 0
    s_sub_u32 s54, s54, s55
    s_lshl_b32 s54, s54, 17
    s_add_u32 s54, s54, s60
    s_add_u32 s55, s54, 7168
    s_add_u32 m0, s61, 32768
    s_nop 0
    buffer_load_dwordx4 v183, s[24:27], s54 offen lds
    buffer_load_dwordx4 v183, s[24:27], s55 offen offset:1024 lds

    s_add_u32 s54, s43, 2
    s_cmp_ge_u32 s54, 14
    s_cselect_b32 s55, 14, 0
    s_sub_u32 s54, s54, s55
    s_lshl_b32 s54, s54, 17
    s_add_u32 s54, s54, s60
    s_add_u32 s55, s54, 7168
    s_add_u32 m0, s61, 65536
    s_nop 0
    buffer_load_dwordx4 v183, s[24:27], s54 offen lds
    buffer_load_dwordx4 v183, s[24:27], s55 offen offset:1024 lds

    s_branch L_fr_back_3
L_fr_gemm_2:
    s_sub_u32 s3, s2, 32
    s_cmp_lg_u32 s18, 4
    s_cbranch_scc1 L_rows_21

    buffer_load_dwordx4 v[64:67], v190, s[20:23], 0 offen offset:0
    buffer_load_dwordx4 v[68:71], v190, s[20:23], 0 offen offset:128
    buffer_load_dwordx4 v[72:75], v190, s[20:23], 0 offen offset:256
    buffer_load_dwordx4 v[76:79], v190, s[20:23], 0 offen offset:384
    buffer_load_dwordx4 v[80:83], v190, s[20:23], 0 offen offset:512
    buffer_load_dwordx4 v[84:87], v190, s[20:23], 0 offen offset:640
    buffer_load_dwordx4 v[88:91], v190, s[20:23], 0 offen offset:768
    buffer_load_dwordx4 v[92:95], v190, s[20:23], 0 offen offset:896
L_rows_21:
    s_lshr_b32 s52, s2, 3
    s_and_b32 s53, s2, 7
    v_lshrrev_b32 v3, 3, v1
    v_and_b32 v4, 7, v1
    s_lshl_b32 s54, s52, 6
    s_lshl_b32 s55, s18, 3
    s_add_u32 s54, s54, s55
    v_add_u32 v5, s54, v3
    v_lshlrev_b32 v5, 10, v5
    v_lshl_add_u32 v5, v4, 4, v5
    s_lshl_b32 s55, s53, 7
    v_add_u32 v5, s55, v5
    v_subrev_u32 v6, 8192, v5
    v_and_b32 v7, 31, v0
    v_lshlrev_b32 v7, 4, v7
    s_lshl_b32 s54, s53, 9
    v_add_u32 v7, s54, v7
    s_mov_b32 s60, s6
    s_mov_b32 s61, s7

    s_mov_b32 s4, s60
    s_mov_b32 s5, s61
    s_mov_b32 s6, 2097152
    s_mov_b32 s7, 0x00020000
    s_lshl_b32 s54, s18, 10
    s_add_u32 m0, s54, 131072
    s_cmp_lg_u32 s18, 7
    buffer_load_dwordx4 v6, s[4:7], 0 offen lds

    s_cbranch_scc1 L_kv_no9_22
    s_mov_b32 m0, 139264
    s_nop 0
    buffer_load_dwordx4 v5, s[4:7], 0 offen lds

L_kv_no9_22:
    s_mov_b32 s4, s8
    s_mov_b32 s5, s9
    s_add_u32 m0, s54, 140288
    s_nop 0
    buffer_load_dwordx4 v5, s[4:7], 0 offen lds
    s_mov_b32 s4, s10
    s_mov_b32 s5, s11
    s_mov_b32 s6, 4096
    buffer_load_dwordx4 v[124:127], v7, s[4:7], 0 offen

    s_barrier
    s_and_b32 s34, s3, 7
    s_lshr_b32 s35, s3, 3
    s_mul_hi_u32 s32, s35, 0x24924925
    s_mul_i32 s33, s32, 7
    s_sub_u32 s33, s35, s33
    s_and_b32 s35, s34, 1
    s_mul_i32 s35, s35, 7
    s_add_u32 s33, s33, s35
    s_lshr_b32 s34, s34, 1
    s_lshl_b32 s34, s34, 2
    s_add_u32 s32, s32, s34

    v_lshrrev_b32 v2, 3, v1
    v_lshrrev_b32 v3, 4, v1
    v_and_b32 v4, 7, v1
    s_lshl_b32 s38, s32, 7
    s_lshl_b32 s39, s18, 4
    s_add_u32 s38, s38, s39
    v_add_u32 v5, s38, v2
    v_lshlrev_b32 v5, 10, v5
    v_xor_b32 v6, v4, v3
    v_lshl_add_u32 v134, v6, 4, v5
    v_xor_b32 v6, 4, v6
    v_lshl_add_u32 v135, v6, 4, v5
    v_add_u32 v135, 8192, v135
    s_lshl_b32 s39, s18, 3
    v_add_u32 v5, s39, v3
    v_mul_u32_u24 v5, 3584, v5
    v_and_b32 v6, 15, v1
    v_lshlrev_b32 v7, 2, v3
    v_xor_b32 v6, v6, v7
    v_lshl_add_u32 v5, v6, 4, v5
    s_lshl_b32 s39, s33, 8
    v_add_u32 v136, s39, v5
    s_lshl_b32 s40, s18, 11
    s_and_b32 s41, s32, 1
    s_lshl_b32 s41, s41, 2
    s_add_u32 s41, s41, s33
    s_and_b32 s41, s41, 0
    s_mul_i32 s42, s41, 229376
    s_lshl_b32 s41, s41, 7

    s_mov_b32 m0, s40
    s_add_u32 s44, s42, 14336
    buffer_load_dwordx4 v134, s[20:23], s41 offen lds
    s_add_u32 m0, s40, 1024
    s_nop 0
    buffer_load_dwordx4 v135, s[20:23], s41 offen lds
    s_add_u32 m0, s40, 16384
    s_add_u32 s41, s41, 128
    buffer_load_dwordx4 v136, s[24:27], s42 offen lds
    s_add_u32 m0, s40, 17408
    s_add_u32 s42, s42, 229376
    buffer_load_dwordx4 v136, s[24:27], s44 offen lds
    s_add_u32 s40, s40, 32768
    s_and_b32 s40, s40, 0x1ffff
    s_and_b32 s41, s41, 1023
    s_cselect_b32 s42, s42, 0
    s_mov_b32 m0, s40
    s_add_u32 s44, s42, 14336
    buffer_load_dwordx4 v134, s[20:23], s41 offen lds
    s_add_u32 m0, s40, 1024
    s_nop 0
    buffer_load_dwordx4 v135, s[20:23], s41 offen lds
    s_add_u32 m0, s40, 16384
    s_add_u32 s41, s41, 128
    buffer_load_dwordx4 v136, s[24:27], s42 offen lds
    s_add_u32 m0, s40, 17408
    s_add_u32 s42, s42, 229376
    buffer_load_dwordx4 v136, s[24:27], s44 offen lds
    s_add_u32 s40, s40, 32768
    s_and_b32 s40, s40, 0x1ffff
    s_and_b32 s41, s41, 1023
    s_cselect_b32 s42, s42, 0
    s_mov_b32 s56, s48
    s_mov_b32 s57, s49
    s_mov_b32 s58, 256
    s_mov_b32 s59, 0x00020000
    s_mov_b32 s28, s50
    s_mov_b32 s29, s51
    s_mov_b32 s30, 268435456
    s_mov_b32 s31, 0x00020000
    s_load_dwordx2 s[48:49], s[0:1], 72
    s_load_dwordx4 s[52:55], s[0:1], 32
    s_load_dwordx2 s[8:9], s[0:1], 80

    s_and_b32 s36, s18, 3
    s_lshr_b32 s37, s18, 2
    v_and_b32 v5, 31, v1
    v_lshrrev_b32 v6, 5, v1
    s_lshl_b32 s38, s33, 9
    v_lshl_add_u32 v2, v5, 4, s38
    v_mul_u32_u24 v3, 8192, v6
    v_add3_u32 v148, v2, v3, 0
    v_add_u32 v148, 32768, v148
    s_lshl_b32 s38, s32, 11
    s_add_u32 s38, s38, 131072
    v_and_b32 v2, 15, v1
    v_lshl_add_u32 v2, v2, 7, s38
    s_lshl_b32 s38, s33, 8
    s_add_u32 s38, s38, 163840
    v_and_b32 v3, 1, v1
    v_lshl_add_u32 v3, v3, 7, s38
    v_cmp_gt_u32 vcc, 16, v1
    s_lshr_b32 s38, s2, 5
    s_lshl_b32 s38, s38, 12
    v_cndmask_b32 v150, v3, v2, vcc
    s_add_u32 s38, s38, 196608
    v_lshl_add_u32 v3, v5, 7, s38
    v_cmp_gt_u32 vcc, 32, v1
    v_lshrrev_b32 v4, 1, v5
    v_and_b32 v4, 7, v4
    v_cndmask_b32 v150, v3, v150, vcc
    v_xor_b32 v2, v4, v6
    s_lshl_b32 s38, s36, 12
    v_lshl_add_u32 v3, v5, 7, s38

    v_xor_b32 v4, 0, v2
    v_lshl_add_u32 v128, v4, 4, v3
    v_xor_b32 v4, 2, v2
    v_lshl_add_u32 v129, v4, 4, v3
    v_xor_b32 v4, 4, v2
    v_lshl_add_u32 v130, v4, 4, v3
    v_xor_b32 v4, 6, v2
    v_lshl_add_u32 v131, v4, 4, v3
    v_bfe_u32 v2, v1, 2, 2
    v_bfe_u32 v3, v1, 4, 1
    v_and_b32 v4, 3, v1
    v_lshrrev_b32 v7, 1, v4
    v_lshl_add_u32 v7, v3, 1, v7
    v_and_b32 v4, 1, v4
    v_lshlrev_b32 v4, 3, v4
    v_lshl_add_u32 v3, v6, 3, v2
    v_lshl_add_u32 v4, v3, 8, v4
    v_add_u32 v4, 16384, v4
    s_lshl_b32 s38, s37, 1

    s_add_u32 s39, s38, 0
    v_xor_b32 v3, s39, v2
    v_lshl_add_u32 v3, v3, 2, v7
    v_lshl_add_u32 v132, v3, 4, v4
    s_add_u32 s39, s38, 1
    v_xor_b32 v3, s39, v2
    v_lshl_add_u32 v3, v3, 2, v7
    v_lshl_add_u32 v133, v3, 4, v4
    v_add_u32 v194, 65536, v128
    v_add_u32 v195, 65536, v129
    v_add_u32 v196, 65536, v130
    v_add_u32 v197, 65536, v131
    v_add_u32 v198, 65536, v132
    v_add_u32 v199, 65536, v133
    v_mov_b32 v2, 161284
    v_mov_b32 v3, 0
    ds_write_b32 v2, v3
    ds_write_b32 v2, v3 offset:4
    ds_write_b32 v2, v3 offset:8
    v_lshrrev_b32 v122, 3, v1
    s_lshl_b32 s38, s18, 3
    v_add_u32 v122, s38, v122
    v_lshrrev_b32 v152, 1, v122
    v_and_b32 v152, 7, v152
    v_and_b32 v155, 7, v1
    v_xor_b32 v152, v152, v155
    v_lshlrev_b32 v152, 4, v152
    v_lshl_add_u32 v152, v122, 7, v152
    v_add_u32 v152, 148480, v152
    s_and_b32 s38, s2, 7
    s_lshl_b32 s38, s38, 6
    v_add_u32 v122, s38, v122
    v_lshlrev_b32 v122, 12, v122
    v_lshl_add_u32 v122, v155, 4, v122

    s_waitcnt lgkmcnt(0)
    s_mov_b32 s50, s52
    s_mov_b32 s51, s53
    s_bfe_u32 s60, s18, 0x10001
    s_lshl_b32 s61, s2, 1
    s_add_u32 s61, s61, s60
    s_lshl_b32 s61, s61, 12
    s_add_u32 s52, s52, s61
    s_addc_u32 s53, s53, 0
    s_load_dword s16, s[52:53], 0
    s_lshl_b32 s61, s2, 2
    s_add_u32 s54, s54, s61
    s_addc_u32 s55, s55, 0
    s_load_dword s17, s[54:55], 0

    s_mov_b32 s63, 0
    s_waitcnt vmcnt(8) lgkmcnt(0)
    s_barrier

    s_cmp_lg_u32 s18, 0
    s_cbranch_scc1 L_g1_nld0_23

    v_mov_b32 v2, 0
    buffer_load_dword v151, v2, s[56:59], 0 offen sc1
L_g1_nld0_23:
    s_mov_b32 m0, s40
    s_add_u32 s44, s42, 14336
    buffer_load_dwordx4 v134, s[20:23], s41 offen lds
    s_add_u32 m0, s40, 1024
    s_nop 0
    buffer_load_dwordx4 v135, s[20:23], s41 offen lds
    s_add_u32 m0, s40, 16384
    s_add_u32 s41, s41, 128
    buffer_load_dwordx4 v136, s[24:27], s42 offen lds
    s_add_u32 m0, s40, 17408
    s_add_u32 s42, s42, 229376
    buffer_load_dwordx4 v136, s[24:27], s44 offen lds
    s_add_u32 s40, s40, 32768
    s_and_b32 s40, s40, 0x1ffff
    s_and_b32 s41, s41, 1023
    s_cselect_b32 s42, s42, 0
    s_cmp_ge_u32 s18, 4
    s_cbranch_scc1 L_g1_stats_24

    v_and_b32 v2, 31, v1
    v_lshrrev_b32 v3, 5, v1
    s_lshl_b32 s52, s18, 1
    v_add_u32 v3, s52, v3
    v_lshlrev_b32 v4, 10, v3
    v_lshl_add_u32 v4, v2, 2, v4
    v_add_u32 v5, 131712, v4
    v_add_u32 v6, 140288, v4

    ds_read_b32 v40, v5 offset:0
    ds_read_b32 v41, v5 offset:128
    ds_read_b32 v42, v5 offset:256
    ds_read_b32 v43, v5 offset:384
    ds_read_b32 v44, v5 offset:512
    ds_read_b32 v45, v5 offset:640
    ds_read_b32 v46, v5 offset:768
    ds_read_b32 v47, v5 offset:896
    ds_read_b32 v48, v5 offset:1024
    ds_read_b32 v49, v5 offset:1152
    ds_read_b32 v50, v5 offset:1280
    v_lshlrev_b32 v102, 16, v124
    v_lshlrev_b32 v103, 16, v126
    v_and_b32 v104, 0xffff0000, v124
    v_and_b32 v105, 0xffff0000, v126
    v_lshlrev_b32 v106, 16, v125
    v_lshlrev_b32 v107, 16, v127
    v_and_b32 v108, 0xffff0000, v125
    v_and_b32 v109, 0xffff0000, v127
    v_sub_u32 v3, 7, v3
    v_and_b32 v7, 7, v2
    v_xor_b32 v3, v3, v7
    v_lshlrev_b32 v3, 4, v3
    v_lshl_add_u32 v3, v2, 8, v3
    v_add_u32 v3, 148480, v3
    s_waitcnt lgkmcnt(4)

    ds_read_b32 v51, v6 offset:0
    ds_read_b32 v52, v6 offset:128
    ds_read_b32 v53, v6 offset:256
    ds_read_b32 v54, v6 offset:384
    ds_read_b32 v55, v6 offset:512
    ds_read_b32 v56, v6 offset:640
    ds_read_b32 v57, v6 offset:768
    ds_read_b32 v58, v6 offset:896
    v_lshlrev_b32 v64, 16, v40
    v_and_b32 v65, 0xffff0000, v40
    v_lshlrev_b32 v66, 16, v41
    v_and_b32 v67, 0xffff0000, v41
    v_lshlrev_b32 v68, 16, v42
    v_and_b32 v69, 0xffff0000, v42
    v_lshlrev_b32 v70, 16, v43
    v_and_b32 v71, 0xffff0000, v43
    v_lshlrev_b32 v72, 16, v44
    v_and_b32 v73, 0xffff0000, v44
    v_lshlrev_b32 v74, 16, v45
    v_and_b32 v75, 0xffff0000, v45
    v_lshlrev_b32 v76, 16, v46
    v_and_b32 v77, 0xffff0000, v46
    s_waitcnt lgkmcnt(8)
    v_lshlrev_b32 v78, 16, v47
    v_and_b32 v79, 0xffff0000, v47
    v_lshlrev_b32 v80, 16, v48
    v_and_b32 v81, 0xffff0000, v48
    v_lshlrev_b32 v82, 16, v49
    v_and_b32 v83, 0xffff0000, v49
    v_lshlrev_b32 v84, 16, v50
    v_and_b32 v85, 0xffff0000, v50
    v_pk_mul_f32 v[8:9], v[64:65], v[108:109]
    v_pk_mul_f32 v[10:11], v[66:67], v[108:109]
    v_pk_mul_f32 v[12:13], v[68:69], v[108:109]
    v_pk_mul_f32 v[14:15], v[70:71], v[108:109]
    v_pk_mul_f32 v[16:17], v[72:73], v[108:109]
    v_pk_mul_f32 v[18:19], v[74:75], v[108:109]
    v_pk_mul_f32 v[20:21], v[76:77], v[108:109]
    v_pk_mul_f32 v[22:23], v[78:79], v[108:109]
    v_pk_fma_f32 v[8:9], v[66:67], v[106:107], v[8:9]
    v_pk_fma_f32 v[10:11], v[68:69], v[106:107], v[10:11]
    v_pk_fma_f32 v[12:13], v[70:71], v[106:107], v[12:13]
    v_pk_fma_f32 v[14:15], v[72:73], v[106:107], v[14:15]
    v_pk_fma_f32 v[16:17], v[74:75], v[106:107], v[16:17]
    v_pk_fma_f32 v[18:19], v[76:77], v[106:107], v[18:19]
    v_pk_fma_f32 v[20:21], v[78:79], v[106:107], v[20:21]
    v_pk_fma_f32 v[22:23], v[80:81], v[106:107], v[22:23]
    v_pk_fma_f32 v[8:9], v[68:69], v[104:105], v[8:9]
    v_pk_fma_f32 v[10:11], v[70:71], v[104:105], v[10:11]
    v_pk_fma_f32 v[12:13], v[72:73], v[104:105], v[12:13]
    v_pk_fma_f32 v[14:15], v[74:75], v[104:105], v[14:15]
    v_pk_fma_f32 v[16:17], v[76:77], v[104:105], v[16:17]
    v_pk_fma_f32 v[18:19], v[78:79], v[104:105], v[18:19]
    v_pk_fma_f32 v[20:21], v[80:81], v[104:105], v[20:21]
    v_pk_fma_f32 v[22:23], v[82:83], v[104:105], v[22:23]
    v_pk_fma_f32 v[8:9], v[70:71], v[102:103], v[8:9]
    v_pk_fma_f32 v[10:11], v[72:73], v[102:103], v[10:11]
    v_pk_fma_f32 v[12:13], v[74:75], v[102:103], v[12:13]
    v_pk_fma_f32 v[14:15], v[76:77], v[102:103], v[14:15]
    v_pk_fma_f32 v[16:17], v[78:79], v[102:103], v[16:17]
    v_pk_fma_f32 v[18:19], v[80:81], v[102:103], v[18:19]
    v_pk_fma_f32 v[20:21], v[82:83], v[102:103], v[20:21]
    v_pk_fma_f32 v[22:23], v[84:85], v[102:103], v[22:23]
    s_waitcnt lgkmcnt(0)
    v_lshlrev_b32 v86, 16, v51
    v_and_b32 v87, 0xffff0000, v51
    v_lshlrev_b32 v88, 16, v52
    v_and_b32 v89, 0xffff0000, v52
    v_lshlrev_b32 v90, 16, v53
    v_and_b32 v91, 0xffff0000, v53
    v_lshlrev_b32 v92, 16, v54
    v_and_b32 v93, 0xffff0000, v54
    v_lshlrev_b32 v94, 16, v55
    v_and_b32 v95, 0xffff0000, v55
    v_lshlrev_b32 v96, 16, v56
    v_and_b32 v97, 0xffff0000, v56
    v_lshlrev_b32 v98, 16, v57
    v_and_b32 v99, 0xffff0000, v57
    v_lshlrev_b32 v100, 16, v58
    v_and_b32 v101, 0xffff0000, v58
    v_pk_mul_f32 v[8:9], v[8:9], v[86:87]
    v_pk_mul_f32 v[10:11], v[10:11], v[88:89]
    v_pk_mul_f32 v[12:13], v[12:13], v[90:91]
    v_pk_mul_f32 v[14:15], v[14:15], v[92:93]
    v_pk_mul_f32 v[16:17], v[16:17], v[94:95]
    v_pk_mul_f32 v[18:19], v[18:19], v[96:97]
    v_pk_mul_f32 v[20:21], v[20:21], v[98:99]
    v_pk_mul_f32 v[22:23], v[22:23], v[100:101]
    v_cvt_pk_bf16_f32 v24, v22, v20
    v_cvt_pk_bf16_f32 v25, v18, v16
    v_cvt_pk_bf16_f32 v26, v14, v12
    v_cvt_pk_bf16_f32 v27, v10, v8
    ds_write_b128 v3, v[24:27] offset:0
    v_cvt_pk_bf16_f32 v28, v23, v21
    v_cvt_pk_bf16_f32 v29, v19, v17
    v_cvt_pk_bf16_f32 v30, v15, v13
    v_cvt_pk_bf16_f32 v31, v11, v9
    ds_write_b128 v3, v[28:31] offset:128
    s_branch L_g1_pro_25
L_g1_stats_24:
    s_cmp_lg_u32 s18, 4
    s_cbranch_scc1 L_g1_pro_25

    v_mov_b32 v104, 0x3f803f80
    s_nop 0
    v_dot2_f32_bf16 v96, v64, v104, 0
    v_dot2_f32_bf16 v100, v64, v64, 0
    v_dot2_f32_bf16 v97, v65, v104, 0
    v_dot2_f32_bf16 v101, v65, v65, 0
    v_dot2_f32_bf16 v98, v66, v104, 0
    v_dot2_f32_bf16 v102, v66, v66, 0
    v_dot2_f32_bf16 v99, v67, v104, 0
    v_dot2_f32_bf16 v103, v67, v67, 0
    v_dot2_f32_bf16 v96, v68, v104, v96
    v_dot2_f32_bf16 v100, v68, v68, v100
    v_dot2_f32_bf16 v97, v69, v104, v97
    v_dot2_f32_bf16 v101, v69, v69, v101
    v_dot2_f32_bf16 v98, v70, v104, v98
    v_dot2_f32_bf16 v102, v70, v70, v102
    v_dot2_f32_bf16 v99, v71, v104, v99
    v_dot2_f32_bf16 v103, v71, v71, v103
    v_dot2_f32_bf16 v96, v72, v104, v96
    v_dot2_f32_bf16 v100, v72, v72, v100
    v_dot2_f32_bf16 v97, v73, v104, v97
    v_dot2_f32_bf16 v101, v73, v73, v101
    v_dot2_f32_bf16 v98, v74, v104, v98
    v_dot2_f32_bf16 v102, v74, v74, v102
    v_dot2_f32_bf16 v99, v75, v104, v99
    v_dot2_f32_bf16 v103, v75, v75, v103
    v_dot2_f32_bf16 v96, v76, v104, v96
    v_dot2_f32_bf16 v100, v76, v76, v100
    v_dot2_f32_bf16 v97, v77, v104, v97
    v_dot2_f32_bf16 v101, v77, v77, v101
    v_dot2_f32_bf16 v98, v78, v104, v98
    v_dot2_f32_bf16 v102, v78, v78, v102
    v_dot2_f32_bf16 v99, v79, v104, v99
    v_dot2_f32_bf16 v103, v79, v79, v103
    v_dot2_f32_bf16 v96, v80, v104, v96
    v_dot2_f32_bf16 v100, v80, v80, v100
    v_dot2_f32_bf16 v97, v81, v104, v97
    v_dot2_f32_bf16 v101, v81, v81, v101
    v_dot2_f32_bf16 v98, v82, v104, v98
    v_dot2_f32_bf16 v102, v82, v82, v102
    v_dot2_f32_bf16 v99, v83, v104, v99
    v_dot2_f32_bf16 v103, v83, v83, v103
    v_dot2_f32_bf16 v96, v84, v104, v96
    v_dot2_f32_bf16 v100, v84, v84, v100
    v_dot2_f32_bf16 v97, v85, v104, v97
    v_dot2_f32_bf16 v101, v85, v85, v101
    v_dot2_f32_bf16 v98, v86, v104, v98
    v_dot2_f32_bf16 v102, v86, v86, v102
    v_dot2_f32_bf16 v99, v87, v104, v99
    v_dot2_f32_bf16 v103, v87, v87, v103
    v_dot2_f32_bf16 v96, v88, v104, v96
    v_dot2_f32_bf16 v100, v88, v88, v100
    v_dot2_f32_bf16 v97, v89, v104, v97
    v_dot2_f32_bf16 v101, v89, v89, v101
    v_dot2_f32_bf16 v98, v90, v104, v98
    v_dot2_f32_bf16 v102, v90, v90, v102
    v_dot2_f32_bf16 v99, v91, v104, v99
    v_dot2_f32_bf16 v103, v91, v91, v103
    v_dot2_f32_bf16 v96, v92, v104, v96
    v_dot2_f32_bf16 v100, v92, v92, v100
    v_dot2_f32_bf16 v97, v93, v104, v97
    v_dot2_f32_bf16 v101, v93, v93, v101
    v_dot2_f32_bf16 v98, v94, v104, v98
    v_dot2_f32_bf16 v102, v94, v94, v102
    v_dot2_f32_bf16 v99, v95, v104, v99
    v_dot2_f32_bf16 v103, v95, v95, v103
    s_nop 2
    v_add_f32 v96, v96, v97
    v_add_f32 v98, v98, v99
    v_add_f32 v100, v100, v101
    v_add_f32 v102, v102, v103
    v_add_f32 v96, v96, v98
    v_add_f32 v100, v100, v102

    s_nop 1
    v_add_f32_dpp v96, v96, v96 quad_perm:[1,0,3,2] row_mask:0xf bank_mask:0xf
    v_add_f32_dpp v100, v100, v100 quad_perm:[1,0,3,2] row_mask:0xf bank_mask:0xf
    s_nop 1
    v_add_f32_dpp v96, v96, v96 quad_perm:[2,3,0,1] row_mask:0xf bank_mask:0xf
    v_add_f32_dpp v100, v100, v100 quad_perm:[2,3,0,1] row_mask:0xf bank_mask:0xf
    s_nop 1
    v_add_f32_dpp v96, v96, v96 row_half_mirror row_mask:0xf bank_mask:0xf
    v_add_f32_dpp v100, v100, v100 row_half_mirror row_mask:0xf bank_mask:0xf
    v_mul_f32 v97, 0x3b000000, v96
    v_mul_f32 v100, 0x3b000000, v100
    v_fma_f32 v100, -v97, v97, v100
    v_max_f32 v100, 0, v100

    v_cvt_pk_bf16_f32 v100, v100, v100
    v_and_b32 v100, 0xffff0000, v100
    v_add_f32 v100, 0x3727c5ac, v100
    v_cvt_pk_bf16_f32 v100, v100, v100
    v_and_b32 v100, 0xffff0000, v100
    v_sqrt_f32 v100, v100
    s_nop 0
    v_cvt_pk_bf16_f32 v100, v100, v100
    v_and_b32 v100, 0xffff0000, v100
    v_rcp_f32 v99, v100
    v_cvt_pk_bf16_f32 v98, v97, v97
    v_and_b32 v98, 0xffff0000, v98
    v_lshrrev_b32 v3, 3, v1
    s_lshl_b32 s52, s2, 3
    v_add_lshl_u32 v3, v3, s52, 3
    v_and_b32 v4, 7, v1
    v_cmp_eq_u32 vcc, 0, v4
    s_and_saveexec_b64 s[60:61], vcc
    buffer_store_dwordx2 v[98:99], v3, s[28:31], 0 offen offset:0 sc1
    s_mov_b64 exec, s[60:61]

L_g1_pro_25:
    v_mov_b32 v8, 0
    v_mov_b32 v9, 0
    v_mov_b32 v10, 0
    v_mov_b32 v11, 0
    v_mov_b32 v12, 0
    v_mov_b32 v13, 0
    v_mov_b32 v14, 0
    v_mov_b32 v15, 0
    v_mov_b32 v16, 0
    v_mov_b32 v17, 0
    v_mov_b32 v18, 0
    v_mov_b32 v19, 0
    v_mov_b32 v20, 0
    v_mov_b32 v21, 0
    v_mov_b32 v22, 0
    v_mov_b32 v23, 0
    v_mov_b32 v24, 0
    v_mov_b32 v25, 0
    v_mov_b32 v26, 0
    v_mov_b32 v27, 0
    v_mov_b32 v28, 0
    v_mov_b32 v29, 0
    v_mov_b32 v30, 0
    v_mov_b32 v31, 0
    v_mov_b32 v32, 0
    v_mov_b32 v33, 0
    v_mov_b32 v34, 0
    v_mov_b32 v35, 0
    v_mov_b32 v36, 0
    v_mov_b32 v37, 0
    v_mov_b32 v38, 0
    v_mov_b32 v39, 0
    s_waitcnt vmcnt(8) lgkmcnt(0)
    s_barrier

    ds_read_b128 v[64:67], v152
    ds_read_b128 v[40:43], v128 offset:0
    ds_read_b64_tr_b16 v[44:45], v132 offset:0
    ds_read_b64_tr_b16 v[46:47], v132 offset:1024
    ds_read_b64_tr_b16 v[48:49], v133 offset:0
    ds_read_b64_tr_b16 v[50:51], v133 offset:1024
    ds_read_b128 v[52:55], v129 offset:0
    ds_read_b64_tr_b16 v[56:57], v132 offset:4096
    ds_read_b64_tr_b16 v[58:59], v132 offset:5120
    ds_read_b64_tr_b16 v[60:61], v133 offset:4096
    ds_read_b64_tr_b16 v[62:63], v133 offset:5120
    s_waitcnt lgkmcnt(5)
    v_mfma_f32_32x32x16_bf16 v[8:23], v[44:47], v[40:43], v[8:23]
    ds_read_b128 v[168:171], v130 offset:0
    ds_read_b64_tr_b16 v[172:173], v132 offset:8192
    ds_read_b64_tr_b16 v[174:175], v132 offset:9216
    s_mov_b32 m0, s40
    s_add_u32 s44, s42, 14336
    buffer_load_dwordx4 v134, s[20:23], s41 offen lds
    v_mfma_f32_32x32x16_bf16 v[24:39], v[48:51], v[40:43], v[24:39]
    ds_read_b64_tr_b16 v[176:177], v133 offset:8192
    ds_read_b64_tr_b16 v[178:179], v133 offset:9216
    s_waitcnt lgkmcnt(5)
    v_mfma_f32_32x32x16_bf16 v[8:23], v[56:59], v[52:55], v[8:23]
    ds_read_b128 v[180:183], v131 offset:0
    ds_read_b64_tr_b16 v[184:185], v132 offset:12288
    ds_read_b64_tr_b16 v[186:187], v132 offset:13312
    s_add_u32 m0, s40, 1024
    s_nop 0
    buffer_load_dwordx4 v135, s[20:23], s41 offen lds
    v_mfma_f32_32x32x16_bf16 v[24:39], v[60:63], v[52:55], v[24:39]
    ds_read_b64_tr_b16 v[188:189], v133 offset:12288
    ds_read_b64_tr_b16 v[190:191], v133 offset:13312
    s_lshr_b32 s52, s2, 3
    s_lshl_b32 s52, s52, 7
    s_sub_u32 s52, 1052544, s52
    buffer_store_dwordx4 v[64:67], v122, s[28:31], s52 offen sc1

    s_waitcnt vmcnt(7)
    s_barrier
    s_waitcnt lgkmcnt(5)
    v_mfma_f32_32x32x16_bf16 v[8:23], v[172:175], v[168:171], v[8:23]
    ds_read_b128 v[40:43], v128 offset:32768
    ds_read_b64_tr_b16 v[44:45], v132 offset:32768
    ds_read_b64_tr_b16 v[46:47], v132 offset:33792
    s_add_u32 m0, s40, 16384
    s_add_u32 s41, s41, 128
    buffer_load_dwordx4 v136, s[24:27], s42 offen lds
    v_mfma_f32_32x32x16_bf16 v[24:39], v[176:179], v[168:171], v[24:39]
    ds_read_b64_tr_b16 v[48:49], v133 offset:32768
    ds_read_b64_tr_b16 v[50:51], v133 offset:33792
    s_waitcnt lgkmcnt(5)
    v_mfma_f32_32x32x16_bf16 v[8:23], v[184:187], v[180:183], v[8:23]
    ds_read_b128 v[52:55], v129 offset:32768
    ds_read_b64_tr_b16 v[56:57], v132 offset:36864
    ds_read_b64_tr_b16 v[58:59], v132 offset:37888
    s_add_u32 m0, s40, 17408
    s_add_u32 s42, s42, 229376
    buffer_load_dwordx4 v136, s[24:27], s44 offen lds
    s_add_u32 s40, s40, 32768
    s_and_b32 s40, s40, 0x1ffff
    s_and_b32 s41, s41, 1023
    s_cselect_b32 s42, s42, 0
    v_mfma_f32_32x32x16_bf16 v[24:39], v[188:191], v[180:183], v[24:39]
    ds_read_b64_tr_b16 v[60:61], v133 offset:36864
    ds_read_b64_tr_b16 v[62:63], v133 offset:37888
    s_waitcnt lgkmcnt(5)
    v_mfma_f32_32x32x16_bf16 v[8:23], v[44:47], v[40:43], v[8:23]
    ds_read_b128 v[168:171], v130 offset:32768
    ds_read_b64_tr_b16 v[172:173], v132 offset:40960
    ds_read_b64_tr_b16 v[174:175], v132 offset:41984
    s_mov_b32 m0, s40
    s_add_u32 s44, s42, 14336
    buffer_load_dwordx4 v134, s[20:23], s41 offen lds
    v_mfma_f32_32x32x16_bf16 v[24:39], v[48:51], v[40:43], v[24:39]
    ds_read_b64_tr_b16 v[176:177], v133 offset:40960
    ds_read_b64_tr_b16 v[178:179], v133 offset:41984
    s_waitcnt lgkmcnt(5)
    v_mfma_f32_32x32x16_bf16 v[8:23], v[56:59], v[52:55], v[8:23]
    ds_read_b128 v[180:183], v131 offset:32768
    ds_read_b64_tr_b16 v[184:185], v132 offset:45056
    ds_read_b64_tr_b16 v[186:187], v132 offset:46080
    s_add_u32 m0, s40, 1024
    s_nop 0
    buffer_load_dwordx4 v135, s[20:23], s41 offen lds
    v_mfma_f32_32x32x16_bf16 v[24:39], v[60:63], v[52:55], v[24:39]
    ds_read_b64_tr_b16 v[188:189], v133 offset:45056
    ds_read_b64_tr_b16 v[190:191], v133 offset:46080
    s_waitcnt vmcnt(7)
    s_barrier
    s_waitcnt lgkmcnt(5)
    v_mfma_f32_32x32x16_bf16 v[8:23], v[172:175], v[168:171], v[8:23]
    ds_read_b128 v[40:43], v194 offset:0
    ds_read_b64_tr_b16 v[44:45], v198 offset:0
    ds_read_b64_tr_b16 v[46:47], v198 offset:1024
    s_add_u32 m0, s40, 16384
    s_add_u32 s41, s41, 128
    buffer_load_dwordx4 v136, s[24:27], s42 offen lds
    v_mfma_f32_32x32x16_bf16 v[24:39], v[176:179], v[168:171], v[24:39]
    ds_read_b64_tr_b16 v[48:49], v199 offset:0
    ds_read_b64_tr_b16 v[50:51], v199 offset:1024
    s_waitcnt lgkmcnt(5)
    v_mfma_f32_32x32x16_bf16 v[8:23], v[184:187], v[180:183], v[8:23]
    ds_read_b128 v[52:55], v195 offset:0
    ds_read_b64_tr_b16 v[56:57], v198 offset:4096
    ds_read_b64_tr_b16 v[58:59], v198 offset:5120
    s_add_u32 m0, s40, 17408
    s_add_u32 s42, s42, 229376
    buffer_load_dwordx4 v136, s[24:27], s44 offen lds
    s_add_u32 s40, s40, 32768
    s_and_b32 s40, s40, 0x1ffff
    s_and_b32 s41, s41, 1023
    s_cselect_b32 s42, s42, 0
    v_mfma_f32_32x32x16_bf16 v[24:39], v[188:191], v[180:183], v[24:39]
    ds_read_b64_tr_b16 v[60:61], v199 offset:4096
    ds_read_b64_tr_b16 v[62:63], v199 offset:5120
    s_cmp_eq_u32 s18, 0
    s_cbranch_scc1 L_g1_post_out_26
L_g1_post_back_27:
    s_waitcnt lgkmcnt(5)
    v_mfma_f32_32x32x16_bf16 v[8:23], v[44:47], v[40:43], v[8:23]
    ds_read_b128 v[168:171], v196 offset:0
    ds_read_b64_tr_b16 v[172:173], v198 offset:8192
    ds_read_b64_tr_b16 v[174:175], v198 offset:9216
    s_mov_b32 m0, s40
    s_add_u32 s44, s42, 14336
    buffer_load_dwordx4 v134, s[20:23], s41 offen lds
    v_mfma_f32_32x32x16_bf16 v[24:39], v[48:51], v[40:43], v[24:39]
    ds_read_b64_tr_b16 v[176:177], v199 offset:8192
    ds_read_b64_tr_b16 v[178:179], v199 offset:9216
    s_waitcnt lgkmcnt(5)
    v_mfma_f32_32x32x16_bf16 v[8:23], v[56:59], v[52:55], v[8:23]
    ds_read_b128 v[180:183], v197 offset:0
    ds_read_b64_tr_b16 v[184:185], v198 offset:12288
    ds_read_b64_tr_b16 v[186:187], v198 offset:13312
    s_add_u32 m0, s40, 1024
    s_nop 0
    buffer_load_dwordx4 v135, s[20:23], s41 offen lds
    v_mfma_f32_32x32x16_bf16 v[24:39], v[60:63], v[52:55], v[24:39]
    ds_read_b64_tr_b16 v[188:189], v199 offset:12288
    ds_read_b64_tr_b16 v[190:191], v199 offset:13312
    s_waitcnt vmcnt(6)
    s_barrier
    s_waitcnt lgkmcnt(5)
    v_mfma_f32_32x32x16_bf16 v[8:23], v[172:175], v[168:171], v[8:23]
    ds_read_b128 v[40:43], v194 offset:32768
    ds_read_b64_tr_b16 v[44:45], v198 offset:32768
    ds_read_b64_tr_b16 v[46:47], v198 offset:33792
    s_add_u32 m0, s40, 16384
    s_add_u32 s41, s41, 128
    buffer_load_dwordx4 v136, s[24:27], s42 offen lds
    v_mfma_f32_32x32x16_bf16 v[24:39], v[176:179], v[168:171], v[24:39]
    ds_read_b64_tr_b16 v[48:49], v199 offset:32768
    ds_read_b64_tr_b16 v[50:51], v199 offset:33792
    s_waitcnt lgkmcnt(5)
    v_mfma_f32_32x32x16_bf16 v[8:23], v[184:187], v[180:183], v[8:23]
    ds_read_b128 v[52:55], v195 offset:32768
    ds_read_b64_tr_b16 v[56:57], v198 offset:36864
    ds_read_b64_tr_b16 v[58:59], v198 offset:37888
    s_add_u32 m0, s40, 17408
    s_add_u32 s42, s42, 229376
    buffer_load_dwordx4 v136, s[24:27], s44 offen lds
    s_add_u32 s40, s40, 32768
    s_and_b32 s40, s40, 0x1ffff
    s_and_b32 s41, s41, 1023
    s_cselect_b32 s42, s42, 0
    v_mfma_f32_32x32x16_bf16 v[24:39], v[188:191], v[180:183], v[24:39]
    ds_read_b64_tr_b16 v[60:61], v199 offset:36864
    ds_read_b64_tr_b16 v[62:63], v199 offset:37888
    s_cmp_eq_u32 s18, 0
    s_cbranch_scc1 L_g1_kvf_out_28
L_g1_kvf_back_29:
    s_waitcnt lgkmcnt(5)
    v_mfma_f32_32x32x16_bf16 v[8:23], v[44:47], v[40:43], v[8:23]
    ds_read_b128 v[168:171], v196 offset:32768
    ds_read_b64_tr_b16 v[172:173], v198 offset:40960
    ds_read_b64_tr_b16 v[174:175], v198 offset:41984
    s_mov_b32 m0, s40
    s_add_u32 s44, s42, 14336
    buffer_load_dwordx4 v134, s[20:23], s41 offen lds
    v_mfma_f32_32x32x16_bf16 v[24:39], v[48:51], v[40:43], v[24:39]
    ds_read_b64_tr_b16 v[176:177], v199 offset:40960
    ds_read_b64_tr_b16 v[178:179], v199 offset:41984
    s_waitcnt lgkmcnt(5)
    v_mfma_f32_32x32x16_bf16 v[8:23], v[56:59], v[52:55], v[8:23]
    ds_read_b128 v[180:183], v197 offset:32768
    ds_read_b64_tr_b16 v[184:185], v198 offset:45056
    ds_read_b64_tr_b16 v[186:187], v198 offset:46080
    s_add_u32 m0, s40, 1024
    s_nop 0
    buffer_load_dwordx4 v135, s[20:23], s41 offen lds
    v_mfma_f32_32x32x16_bf16 v[24:39], v[60:63], v[52:55], v[24:39]
    ds_read_b64_tr_b16 v[188:189], v199 offset:45056
    ds_read_b64_tr_b16 v[190:191], v199 offset:46080
    s_waitcnt vmcnt(6)
    s_barrier
    s_waitcnt lgkmcnt(5)
    v_mfma_f32_32x32x16_bf16 v[8:23], v[172:175], v[168:171], v[8:23]
    ds_read_b128 v[40:43], v128 offset:0
    ds_read_b64_tr_b16 v[44:45], v132 offset:0
    ds_read_b64_tr_b16 v[46:47], v132 offset:1024
    s_add_u32 m0, s40, 16384
    s_add_u32 s41, s41, 128
    buffer_load_dwordx4 v136, s[24:27], s42 offen lds
    v_mfma_f32_32x32x16_bf16 v[24:39], v[176:179], v[168:171], v[24:39]
    ds_read_b64_tr_b16 v[48:49], v133 offset:0
    ds_read_b64_tr_b16 v[50:51], v133 offset:1024
    s_waitcnt lgkmcnt(5)
    v_mfma_f32_32x32x16_bf16 v[8:23], v[184:187], v[180:183], v[8:23]
    ds_read_b128 v[52:55], v129 offset:0
    ds_read_b64_tr_b16 v[56:57], v132 offset:4096
    ds_read_b64_tr_b16 v[58:59], v132 offset:5120
    s_add_u32 m0, s40, 17408
    s_add_u32 s42, s42, 229376
    buffer_load_dwordx4 v136, s[24:27], s44 offen lds
    s_add_u32 s40, s40, 32768
    s_and_b32 s40, s40, 0x1ffff
    s_and_b32 s41, s41, 1023
    s_cselect_b32 s42, s42, 0
    v_mfma_f32_32x32x16_bf16 v[24:39], v[188:191], v[180:183], v[24:39]
    ds_read_b64_tr_b16 v[60:61], v133 offset:4096
    ds_read_b64_tr_b16 v[62:63], v133 offset:5120
    s_waitcnt lgkmcnt(5)
    v_mfma_f32_32x32x16_bf16 v[8:23], v[44:47], v[40:43], v[8:23]
    ds_read_b128 v[168:171], v130 offset:0
    ds_read_b64_tr_b16 v[172:173], v132 offset:8192
    ds_read_b64_tr_b16 v[174:175], v132 offset:9216
    s_mov_b32 m0, s40
    s_add_u32 s44, s42, 14336
    buffer_load_dwordx4 v134, s[20:23], s41 offen lds
    v_mfma_f32_32x32x16_bf16 v[24:39], v[48:51], v[40:43], v[24:39]
    ds_read_b64_tr_b16 v[176:177], v133 offset:8192
    ds_read_b64_tr_b16 v[178:179], v133 offset:9216
    s_waitcnt lgkmcnt(5)
    v_mfma_f32_32x32x16_bf16 v[8:23], v[56:59], v[52:55], v[8:23]
    ds_read_b128 v[180:183], v131 offset:0
    ds_read_b64_tr_b16 v[184:185], v132 offset:12288
    ds_read_b64_tr_b16 v[186:187], v132 offset:13312
    s_add_u32 m0, s40, 1024
    s_nop 0
    buffer_load_dwordx4 v135, s[20:23], s41 offen lds
    v_mfma_f32_32x32x16_bf16 v[24:39], v[60:63], v[52:55], v[24:39]
    ds_read_b64_tr_b16 v[188:189], v133 offset:12288
    ds_read_b64_tr_b16 v[190:191], v133 offset:13312
    s_waitcnt vmcnt(6)
    s_barrier
    s_waitcnt lgkmcnt(5)
    v_mfma_f32_32x32x16_bf16 v[8:23], v[172:175], v[168:171], v[8:23]
    ds_read_b128 v[40:43], v128 offset:32768
    ds_read_b64_tr_b16 v[44:45], v132 offset:32768
    ds_read_b64_tr_b16 v[46:47], v132 offset:33792
    s_add_u32 m0, s40, 16384
    s_add_u32 s41, s41, 128
    buffer_load_dwordx4 v136, s[24:27], s42 offen lds
    v_mfma_f32_32x32x16_bf16 v[24:39], v[176:179], v[168:171], v[24:39]
    ds_read_b64_tr_b16 v[48:49], v133 offset:32768
    ds_read_b64_tr_b16 v[50:51], v133 offset:33792
    s_waitcnt lgkmcnt(5)
    v_mfma_f32_32x32x16_bf16 v[8:23], v[184:187], v[180:183], v[8:23]
    ds_read_b128 v[52:55], v129 offset:32768
    ds_read_b64_tr_b16 v[56:57], v132 offset:36864
    ds_read_b64_tr_b16 v[58:59], v132 offset:37888
    s_add_u32 m0, s40, 17408
    s_add_u32 s42, s42, 229376
    buffer_load_dwordx4 v136, s[24:27], s44 offen lds
    s_add_u32 s40, s40, 32768
    s_and_b32 s40, s40, 0x1ffff
    s_and_b32 s41, s41, 1023
    s_cselect_b32 s42, s42, 0
    v_mfma_f32_32x32x16_bf16 v[24:39], v[188:191], v[180:183], v[24:39]
    ds_read_b64_tr_b16 v[60:61], v133 offset:36864
    ds_read_b64_tr_b16 v[62:63], v133 offset:37888
    s_cmp_eq_u32 s18, 0
    s_cbranch_scc1 L_g1_poll1_out_30
L_g1_poll1_back_31:
    s_mov_b32 s44, s50
    s_mov_b32 s45, s51
    s_mov_b32 s46, 2097152
    s_mov_b32 s47, 0x00020000
    s_lshr_b32 s52, s18, 2
    s_bfe_u32 s53, s18, 0x10001
    s_and_b32 s54, s18, 1
    s_lshl_b32 s54, s54, 11
    s_lshl_b32 s55, s53, 1
    v_lshl_add_u32 v2, v1, 4, s55
    s_mul_i32 s53, s53, 4160
    s_mul_i32 s55, s52, 12928
    s_add_u32 s53, s53, s55
    s_add_u32 s53, s53, s54
    s_add_u32 m0, s53, 131104
    s_lshl_b32 s53, s2, 1
    s_add_u32 s53, s53, s52
    s_lshl_b32 s53, s53, 12
    s_add_u32 s53, s53, s54
    buffer_load_dwordx4 v2, s[44:47], s53 offen lds
    buffer_load_dwordx4 v2, s[44:47], s53 offen offset:1024 lds

    s_cmp_lt_u32 s18, 4
    s_cbranch_scc1 L_g1_pads_out_32
L_g1_pads_back_33:
    s_waitcnt lgkmcnt(5)
    v_mfma_f32_32x32x16_bf16 v[8:23], v[44:47], v[40:43], v[8:23]
    ds_read_b128 v[168:171], v130 offset:32768
    ds_read_b64_tr_b16 v[172:173], v132 offset:40960
    ds_read_b64_tr_b16 v[174:175], v132 offset:41984
    v_mfma_f32_32x32x16_bf16 v[24:39], v[48:51], v[40:43], v[24:39]
    ds_read_b64_tr_b16 v[176:177], v133 offset:40960
    ds_read_b64_tr_b16 v[178:179], v133 offset:41984
    s_waitcnt lgkmcnt(5)
    v_mfma_f32_32x32x16_bf16 v[8:23], v[56:59], v[52:55], v[8:23]
    ds_read_b128 v[180:183], v131 offset:32768
    ds_read_b64_tr_b16 v[184:185], v132 offset:45056
    ds_read_b64_tr_b16 v[186:187], v132 offset:46080
    v_mfma_f32_32x32x16_bf16 v[24:39], v[60:63], v[52:55], v[24:39]
    ds_read_b64_tr_b16 v[188:189], v133 offset:45056
    ds_read_b64_tr_b16 v[190:191], v133 offset:46080
    s_waitcnt vmcnt(6)
    s_barrier
    s_waitcnt lgkmcnt(5)
    v_mfma_f32_32x32x16_bf16 v[8:23], v[172:175], v[168:171], v[8:23]
    ds_read_b128 v[40:43], v194 offset:0
    ds_read_b64_tr_b16 v[44:45], v198 offset:0
    ds_read_b64_tr_b16 v[46:47], v198 offset:1024
    v_mfma_f32_32x32x16_bf16 v[24:39], v[176:179], v[168:171], v[24:39]
    ds_read_b64_tr_b16 v[48:49], v199 offset:0
    ds_read_b64_tr_b16 v[50:51], v199 offset:1024
    s_waitcnt lgkmcnt(5)
    v_mfma_f32_32x32x16_bf16 v[8:23], v[184:187], v[180:183], v[8:23]
    ds_read_b128 v[52:55], v195 offset:0
    ds_read_b64_tr_b16 v[56:57], v198 offset:4096
    ds_read_b64_tr_b16 v[58:59], v198 offset:5120
    v_mfma_f32_32x32x16_bf16 v[24:39], v[188:191], v[180:183], v[24:39]
    ds_read_b64_tr_b16 v[60:61], v199 offset:4096
    ds_read_b64_tr_b16 v[62:63], v199 offset:5120
    s_waitcnt lgkmcnt(5)
    v_mfma_f32_32x32x16_bf16 v[8:23], v[44:47], v[40:43], v[8:23]
    ds_read_b128 v[168:171], v196 offset:0
    ds_read_b64_tr_b16 v[172:173], v198 offset:8192
    ds_read_b64_tr_b16 v[174:175], v198 offset:9216
    v_mfma_f32_32x32x16_bf16 v[24:39], v[48:51], v[40:43], v[24:39]
    ds_read_b64_tr_b16 v[176:177], v199 offset:8192
    ds_read_b64_tr_b16 v[178:179], v199 offset:9216
    s_waitcnt lgkmcnt(5)
    v_mfma_f32_32x32x16_bf16 v[8:23], v[56:59], v[52:55], v[8:23]
    ds_read_b128 v[180:183], v197 offset:0
    ds_read_b64_tr_b16 v[184:185], v198 offset:12288
    ds_read_b64_tr_b16 v[186:187], v198 offset:13312
    v_mfma_f32_32x32x16_bf16 v[24:39], v[60:63], v[52:55], v[24:39]
    ds_read_b64_tr_b16 v[188:189], v199 offset:12288
    ds_read_b64_tr_b16 v[190:191], v199 offset:13312
    s_waitcnt vmcnt(2)
    s_barrier
    s_cmp_eq_u32 s18, 0
    s_cbranch_scc1 L_g1_req1_out_34
L_g1_req1_back_35:
    s_waitcnt lgkmcnt(5)
    v_mfma_f32_32x32x16_bf16 v[8:23], v[172:175], v[168:171], v[8:23]
    ds_read_b128 v[40:43], v194 offset:32768
    ds_read_b64_tr_b16 v[44:45], v198 offset:32768
    ds_read_b64_tr_b16 v[46:47], v198 offset:33792
    v_mfma_f32_32x32x16_bf16 v[24:39], v[176:179], v[168:171], v[24:39]
    ds_read_b64_tr_b16 v[48:49], v199 offset:32768
    ds_read_b64_tr_b16 v[50:51], v199 offset:33792
    s_waitcnt lgkmcnt(5)
    v_mfma_f32_32x32x16_bf16 v[8:23], v[184:187], v[180:183], v[8:23]
    ds_read_b128 v[52:55], v195 offset:32768
    ds_read_b64_tr_b16 v[56:57], v198 offset:36864
    ds_read_b64_tr_b16 v[58:59], v198 offset:37888
    v_mfma_f32_32x32x16_bf16 v[24:39], v[188:191], v[180:183], v[24:39]
    ds_read_b64_tr_b16 v[60:61], v199 offset:36864
    ds_read_b64_tr_b16 v[62:63], v199 offset:37888
    s_waitcnt lgkmcnt(5)
    v_mfma_f32_32x32x16_bf16 v[8:23], v[44:47], v[40:43], v[8:23]
    ds_read_b128 v[168:171], v196 offset:32768
    ds_read_b64_tr_b16 v[172:173], v198 offset:40960
    ds_read_b64_tr_b16 v[174:175], v198 offset:41984
    v_mfma_f32_32x32x16_bf16 v[24:39], v[48:51], v[40:43], v[24:39]
    ds_read_b64_tr_b16 v[176:177], v199 offset:40960
    ds_read_b64_tr_b16 v[178:179], v199 offset:41984
    s_waitcnt lgkmcnt(5)
    v_mfma_f32_32x32x16_bf16 v[8:23], v[56:59], v[52:55], v[8:23]
    ds_read_b128 v[180:183], v197 offset:32768
    ds_read_b64_tr_b16 v[184:185], v198 offset:45056
    ds_read_b64_tr_b16 v[186:187], v198 offset:46080
    v_mfma_f32_32x32x16_bf16 v[24:39], v[60:63], v[52:55], v[24:39]
    ds_read_b64_tr_b16 v[188:189], v199 offset:45056
    ds_read_b64_tr_b16 v[190:191], v199 offset:46080
    s_waitcnt lgkmcnt(5)
    v_mfma_f32_32x32x16_bf16 v[8:23], v[172:175], v[168:171], v[8:23]
    v_mfma_f32_32x32x16_bf16 v[24:39], v[176:179], v[168:171], v[24:39]
    s_waitcnt lgkmcnt(0)
    v_mfma_f32_32x32x16_bf16 v[8:23], v[184:187], v[180:183], v[8:23]
    v_mfma_f32_32x32x16_bf16 v[24:39], v[188:191], v[180:183], v[24:39]
    s_cmp_eq_u32 s18, 0
    s_cbranch_scc1 L_g1_fin_out_36
L_g1_fin_back_37:
    v_mov_b32 v140, 1.0
    v_mov_b32 v141, 1.0
    v_mov_b32 v142, 0x3f317218
    v_mov_b32 v143, 0x3f317218
    v_mov_b32 v144, 0xbfb17218
    v_mov_b32 v145, 0xbfb17218
    s_lshl_b32 s38, s32, 2
    s_add_u32 s38, s38, s36
    s_mul_i32 s38, s38, 112
    s_lshl_b32 s39, s33, 3
    s_add_u32 s38, s38, s39
    s_lshl_b32 s39, s37, 2
    s_add_u32 s38, s38, s39
    s_lshl_b32 s38, s38, 10
    s_add_u32 s38, s38, 4194304
    v_and_b32 v5, 31, v1
    s_lshl_b32 s39, s36, 8
    v_lshl_add_u32 v3, v5, 3, s39
    v_add_u32 v3, 157184, v3
    v_lshrrev_b32 v4, 5, v1
    s_lshl_b32 s39, s37, 8
    v_lshl_add_u32 v4, v4, 4, s39
    v_add_u32 v4, 158208, v4
    v_lshlrev_b32 v182, 4, v1

    s_mov_b32 s24, s48
    s_mov_b32 s25, s49
    s_mov_b32 s26, 1835008
    s_mov_b32 s27, 0x00020000
    v_lshrrev_b32 v183, 3, v1
    v_lshlrev_b32 v183, 10, v183
    v_bfe_u32 v184, v1, 4, 1
    v_lshlrev_b32 v184, 2, v184
    v_xor_b32 v184, v184, v1
    v_and_b32 v184, 7, v184
    v_lshl_add_u32 v183, v184, 4, v183
    s_lshl_b32 s60, s18, 14
    s_lshr_b32 s61, s2, 3
    s_and_b32 s61, s61, 7
    s_lshl_b32 s61, s61, 7
    s_add_u32 s60, s60, s61
    s_lshl_b32 s61, s18, 11
    s_add_u32 s61, s61, 16384

    s_and_b32 s52, s2, 7
    s_lshr_b32 s53, s2, 3
    s_lshr_b32 s35, s53, 3
    s_lshl_b32 s52, s52, 2
    s_add_u32 s35, s35, s52
    s_and_b32 s34, s53, 7

    s_lshl_b32 s43, s34, 1
    s_and_b32 s52, s35, 3
    s_mul_i32 s52, s52, 3
    s_add_u32 s43, s43, s52
    s_cmp_ge_u32 s43, 14
    s_cselect_b32 s52, 14, 0
    s_sub_u32 s43, s43, s52

    s_waitcnt vmcnt(0) lgkmcnt(0)
    s_barrier
    ds_read_b64 v[138:139], v3

    ds_read_b128 v[64:67], v4 offset:0
    ds_read_b128 v[96:99], v4 offset:512
    ds_read_b128 v[68:71], v4 offset:32
    ds_read_b128 v[100:103], v4 offset:544
    ds_read_b128 v[72:75], v4 offset:64
    ds_read_b128 v[104:107], v4 offset:576
    ds_read_b128 v[76:79], v4 offset:96
    ds_read_b128 v[108:111], v4 offset:608
    ds_read_b128 v[80:83], v4 offset:128
    ds_read_b128 v[112:115], v4 offset:640
    ds_read_b128 v[84:87], v4 offset:160
    ds_read_b128 v[116:119], v4 offset:672
    ds_read_b128 v[88:91], v4 offset:192
    ds_read_b128 v[120:123], v4 offset:704
    s_waitcnt lgkmcnt(14)
    v_mul_f32 v146, 0x3fb8aa3b, v139
    ds_read_b128 v[92:95], v4 offset:224
    ds_read_b128 v[124:127], v4 offset:736
    s_add_u32 s54, s43, 0
    s_cmp_ge_u32 s54, 14
    s_cselect_b32 s55, 14, 0
    s_sub_u32 s54, s54, s55
    s_lshl_b32 s54, s54, 17
    s_add_u32 s54, s54, s60
    s_add_u32 s55, s54, 7168
    s_add_u32 m0, s61, 0
    s_nop 0
    buffer_load_dwordx4 v183, s[24:27], s54 offen lds
    buffer_load_dwordx4 v183, s[24:27], s55 offen offset:1024 lds

    s_waitcnt lgkmcnt(12)
    v_pk_fma_f32 v[40:41], v[138:139], v[64:65], v[8:9] op_sel_hi:[0,1,1] neg_lo:[1,0,0] neg_hi:[1,0,0]
    v_pk_fma_f32 v[42:43], v[138:139], v[66:67], v[10:11] op_sel_hi:[0,1,1] neg_lo:[1,0,0] neg_hi:[1,0,0]
    v_pk_fma_f32 v[44:45], v[138:139], v[68:69], v[12:13] op_sel_hi:[0,1,1] neg_lo:[1,0,0] neg_hi:[1,0,0]
    v_pk_fma_f32 v[46:47], v[138:139], v[70:71], v[14:15] op_sel_hi:[0,1,1] neg_lo:[1,0,0] neg_hi:[1,0,0]
    v_pk_fma_f32 v[40:41], v[146:147], v[40:41], v[96:97] op_sel_hi:[0,1,1]
    v_pk_fma_f32 v[42:43], v[146:147], v[42:43], v[98:99] op_sel_hi:[0,1,1]
    v_pk_fma_f32 v[44:45], v[146:147], v[44:45], v[100:101] op_sel_hi:[0,1,1]
    v_pk_fma_f32 v[46:47], v[146:147], v[46:47], v[102:103] op_sel_hi:[0,1,1]
    v_exp_f32 v48, v40
    v_exp_f32 v49, v41
    v_exp_f32 v50, v42
    v_exp_f32 v51, v43
    v_exp_f32 v52, v44
    v_exp_f32 v53, v45
    v_exp_f32 v54, v46
    v_exp_f32 v55, v47
    v_pk_add_f32 v[48:49], v[48:49], v[140:141]
    v_pk_add_f32 v[50:51], v[50:51], v[140:141]
    v_pk_add_f32 v[52:53], v[52:53], v[140:141]
    v_pk_add_f32 v[54:55], v[54:55], v[140:141]
    v_pk_fma_f32 v[48:49], v[48:49], v[48:49], v[140:141]
    v_pk_fma_f32 v[50:51], v[50:51], v[50:51], v[140:141]
    v_pk_fma_f32 v[52:53], v[52:53], v[52:53], v[140:141]
    v_pk_fma_f32 v[54:55], v[54:55], v[54:55], v[140:141]
    v_rcp_f32 v48, v48
    v_rcp_f32 v49, v49
    v_rcp_f32 v50, v50
    v_rcp_f32 v51, v51
    v_rcp_f32 v52, v52
    v_rcp_f32 v53, v53
    v_rcp_f32 v54, v54
    v_rcp_f32 v55, v55
    v_pk_fma_f32 v[48:49], v[48:49], v[144:145], v[142:143]
    v_pk_fma_f32 v[50:51], v[50:51], v[144:145], v[142:143]
    v_pk_fma_f32 v[52:53], v[52:53], v[144:145], v[142:143]
    v_pk_fma_f32 v[54:55], v[54:55], v[144:145], v[142:143]
    v_pk_mul_f32 v[40:41], v[40:41], v[48:49]
    v_pk_mul_f32 v[42:43], v[42:43], v[50:51]
    v_pk_mul_f32 v[44:45], v[44:45], v[52:53]
    v_pk_mul_f32 v[46:47], v[46:47], v[54:55]
    v_cvt_pk_bf16_f32 v152, v40, v41
    v_cvt_pk_bf16_f32 v153, v42, v43
    v_cvt_pk_bf16_f32 v154, v44, v45
    v_cvt_pk_bf16_f32 v155, v46, v47
    buffer_store_dwordx4 v[152:155], v182, s[28:31], s38 offen offset:0 sc1
    s_add_u32 s54, s43, 1
    s_cmp_ge_u32 s54, 14
    s_cselect_b32 s55, 14, 0
    s_sub_u32 s54, s54, s55
    s_lshl_b32 s54, s54, 17
    s_add_u32 s54, s54, s60
    s_add_u32 s55, s54, 7168
    s_add_u32 m0, s61, 32768
    s_nop 0
    buffer_load_dwordx4 v183, s[24:27], s54 offen lds
    buffer_load_dwordx4 v183, s[24:27], s55 offen offset:1024 lds

    s_waitcnt lgkmcnt(8)
    v_pk_fma_f32 v[40:41], v[138:139], v[72:73], v[16:17] op_sel_hi:[0,1,1] neg_lo:[1,0,0] neg_hi:[1,0,0]
    v_pk_fma_f32 v[42:43], v[138:139], v[74:75], v[18:19] op_sel_hi:[0,1,1] neg_lo:[1,0,0] neg_hi:[1,0,0]
    v_pk_fma_f32 v[44:45], v[138:139], v[76:77], v[20:21] op_sel_hi:[0,1,1] neg_lo:[1,0,0] neg_hi:[1,0,0]
    v_pk_fma_f32 v[46:47], v[138:139], v[78:79], v[22:23] op_sel_hi:[0,1,1] neg_lo:[1,0,0] neg_hi:[1,0,0]
    v_pk_fma_f32 v[40:41], v[146:147], v[40:41], v[104:105] op_sel_hi:[0,1,1]
    v_pk_fma_f32 v[42:43], v[146:147], v[42:43], v[106:107] op_sel_hi:[0,1,1]
    v_pk_fma_f32 v[44:45], v[146:147], v[44:45], v[108:109] op_sel_hi:[0,1,1]
    v_pk_fma_f32 v[46:47], v[146:147], v[46:47], v[110:111] op_sel_hi:[0,1,1]
    v_exp_f32 v48, v40
    v_exp_f32 v49, v41
    v_exp_f32 v50, v42
    v_exp_f32 v51, v43
    v_exp_f32 v52, v44
    v_exp_f32 v53, v45
    v_exp_f32 v54, v46
    v_exp_f32 v55, v47
    v_pk_add_f32 v[48:49], v[48:49], v[140:141]
    v_pk_add_f32 v[50:51], v[50:51], v[140:141]
    v_pk_add_f32 v[52:53], v[52:53], v[140:141]
    v_pk_add_f32 v[54:55], v[54:55], v[140:141]
    v_pk_fma_f32 v[48:49], v[48:49], v[48:49], v[140:141]
    v_pk_fma_f32 v[50:51], v[50:51], v[50:51], v[140:141]
    v_pk_fma_f32 v[52:53], v[52:53], v[52:53], v[140:141]
    v_pk_fma_f32 v[54:55], v[54:55], v[54:55], v[140:141]
    v_rcp_f32 v48, v48
    v_rcp_f32 v49, v49
    v_rcp_f32 v50, v50
    v_rcp_f32 v51, v51
    v_rcp_f32 v52, v52
    v_rcp_f32 v53, v53
    v_rcp_f32 v54, v54
    v_rcp_f32 v55, v55
    v_pk_fma_f32 v[48:49], v[48:49], v[144:145], v[142:143]
    v_pk_fma_f32 v[50:51], v[50:51], v[144:145], v[142:143]
    v_pk_fma_f32 v[52:53], v[52:53], v[144:145], v[142:143]
    v_pk_fma_f32 v[54:55], v[54:55], v[144:145], v[142:143]
    v_pk_mul_f32 v[40:41], v[40:41], v[48:49]
    v_pk_mul_f32 v[42:43], v[42:43], v[50:51]
    v_pk_mul_f32 v[44:45], v[44:45], v[52:53]
    v_pk_mul_f32 v[46:47], v[46:47], v[54:55]
    v_cvt_pk_bf16_f32 v156, v40, v41
    v_cvt_pk_bf16_f32 v157, v42, v43
    v_cvt_pk_bf16_f32 v158, v44, v45
    v_cvt_pk_bf16_f32 v159, v46, v47
    buffer_store_dwordx4 v[156:159], v182, s[28:31], s38 offen offset:1024 sc1
    s_add_u32 s54, s43, 2
    s_cmp_ge_u32 s54, 14
    s_cselect_b32 s55, 14, 0
    s_sub_u32 s54, s54, s55
    s_lshl_b32 s54, s54, 17
    s_add_u32 s54, s54, s60
    s_add_u32 s55, s54, 7168
    s_add_u32 m0, s61, 65536
    s_nop 0
    buffer_load_dwordx4 v183, s[24:27], s54 offen lds
    buffer_load_dwordx4 v183, s[24:27], s55 offen offset:1024 lds

    s_waitcnt lgkmcnt(4)
    v_pk_fma_f32 v[40:41], v[138:139], v[80:81], v[24:25] op_sel_hi:[0,1,1] neg_lo:[1,0,0] neg_hi:[1,0,0]
    v_pk_fma_f32 v[42:43], v[138:139], v[82:83], v[26:27] op_sel_hi:[0,1,1] neg_lo:[1,0,0] neg_hi:[1,0,0]
    v_pk_fma_f32 v[44:45], v[138:139], v[84:85], v[28:29] op_sel_hi:[0,1,1] neg_lo:[1,0,0] neg_hi:[1,0,0]
    v_pk_fma_f32 v[46:47], v[138:139], v[86:87], v[30:31] op_sel_hi:[0,1,1] neg_lo:[1,0,0] neg_hi:[1,0,0]
    v_pk_fma_f32 v[40:41], v[146:147], v[40:41], v[112:113] op_sel_hi:[0,1,1]
    v_pk_fma_f32 v[42:43], v[146:147], v[42:43], v[114:115] op_sel_hi:[0,1,1]
    v_pk_fma_f32 v[44:45], v[146:147], v[44:45], v[116:117] op_sel_hi:[0,1,1]
    v_pk_fma_f32 v[46:47], v[146:147], v[46:47], v[118:119] op_sel_hi:[0,1,1]
    v_exp_f32 v48, v40
    v_exp_f32 v49, v41
    v_exp_f32 v50, v42
    v_exp_f32 v51, v43
    v_exp_f32 v52, v44
    v_exp_f32 v53, v45
    v_exp_f32 v54, v46
    v_exp_f32 v55, v47
    v_pk_add_f32 v[48:49], v[48:49], v[140:141]
    v_pk_add_f32 v[50:51], v[50:51], v[140:141]
    v_pk_add_f32 v[52:53], v[52:53], v[140:141]
    v_pk_add_f32 v[54:55], v[54:55], v[140:141]
    v_pk_fma_f32 v[48:49], v[48:49], v[48:49], v[140:141]
    v_pk_fma_f32 v[50:51], v[50:51], v[50:51], v[140:141]
    v_pk_fma_f32 v[52:53], v[52:53], v[52:53], v[140:141]
    v_pk_fma_f32 v[54:55], v[54:55], v[54:55], v[140:141]
    v_rcp_f32 v48, v48
    v_rcp_f32 v49, v49
    v_rcp_f32 v50, v50
    v_rcp_f32 v51, v51
    v_rcp_f32 v52, v52
    v_rcp_f32 v53, v53
    v_rcp_f32 v54, v54
    v_rcp_f32 v55, v55
    v_pk_fma_f32 v[48:49], v[48:49], v[144:145], v[142:143]
    v_pk_fma_f32 v[50:51], v[50:51], v[144:145], v[142:143]
    v_pk_fma_f32 v[52:53], v[52:53], v[144:145], v[142:143]
    v_pk_fma_f32 v[54:55], v[54:55], v[144:145], v[142:143]
    v_pk_mul_f32 v[40:41], v[40:41], v[48:49]
    v_pk_mul_f32 v[42:43], v[42:43], v[50:51]
    v_pk_mul_f32 v[44:45], v[44:45], v[52:53]
    v_pk_mul_f32 v[46:47], v[46:47], v[54:55]
    v_cvt_pk_bf16_f32 v160, v40, v41
    v_cvt_pk_bf16_f32 v161, v42, v43
    v_cvt_pk_bf16_f32 v162, v44, v45
    v_cvt_pk_bf16_f32 v163, v46, v47
    buffer_store_dwordx4 v[160:163], v182, s[28:31], s38 offen offset:2048 sc1
    s_waitcnt lgkmcnt(0)
    v_pk_fma_f32 v[40:41], v[138:139], v[88:89], v[32:33] op_sel_hi:[0,1,1] neg_lo:[1,0,0] neg_hi:[1,0,0]
    v_pk_fma_f32 v[42:43], v[138:139], v[90:91], v[34:35] op_sel_hi:[0,1,1] neg_lo:[1,0,0] neg_hi:[1,0,0]
    v_pk_fma_f32 v[44:45], v[138:139], v[92:93], v[36:37] op_sel_hi:[0,1,1] neg_lo:[1,0,0] neg_hi:[1,0,0]
    v_pk_fma_f32 v[46:47], v[138:139], v[94:95], v[38:39] op_sel_hi:[0,1,1] neg_lo:[1,0,0] neg_hi:[1,0,0]
    v_pk_fma_f32 v[40:41], v[146:147], v[40:41], v[120:121] op_sel_hi:[0,1,1]
    v_pk_fma_f32 v[42:43], v[146:147], v[42:43], v[122:123] op_sel_hi:[0,1,1]
    v_pk_fma_f32 v[44:45], v[146:147], v[44:45], v[124:125] op_sel_hi:[0,1,1]
    v_pk_fma_f32 v[46:47], v[146:147], v[46:47], v[126:127] op_sel_hi:[0,1,1]
    v_exp_f32 v48, v40
    v_exp_f32 v49, v41
    v_exp_f32 v50, v42
    v_exp_f32 v51, v43
    v_exp_f32 v52, v44
    v_exp_f32 v53, v45
    v_exp_f32 v54, v46
    v_exp_f32 v55, v47
    v_pk_add_f32 v[48:49], v[48:49], v[140:141]
    v_pk_add_f32 v[50:51], v[50:51], v[140:141]
    v_pk_add_f32 v[52:53], v[52:53], v[140:141]
    v_pk_add_f32 v[54:55], v[54:55], v[140:141]
    v_pk_fma_f32 v[48:49], v[48:49], v[48:49], v[140:141]
    v_pk_fma_f32 v[50:51], v[50:51], v[50:51], v[140:141]
    v_pk_fma_f32 v[52:53], v[52:53], v[52:53], v[140:141]
    v_pk_fma_f32 v[54:55], v[54:55], v[54:55], v[140:141]
    v_rcp_f32 v48, v48
    v_rcp_f32 v49, v49
    v_rcp_f32 v50, v50
    v_rcp_f32 v51, v51
    v_rcp_f32 v52, v52
    v_rcp_f32 v53, v53
    v_rcp_f32 v54, v54
    v_rcp_f32 v55, v55
    v_pk_fma_f32 v[48:49], v[48:49], v[144:145], v[142:143]
    v_pk_fma_f32 v[50:51], v[50:51], v[144:145], v[142:143]
    v_pk_fma_f32 v[52:53], v[52:53], v[144:145], v[142:143]
    v_pk_fma_f32 v[54:55], v[54:55], v[144:145], v[142:143]
    v_pk_mul_f32 v[40:41], v[40:41], v[48:49]
    v_pk_mul_f32 v[42:43], v[42:43], v[50:51]
    v_pk_mul_f32 v[44:45], v[44:45], v[52:53]
    v_pk_mul_f32 v[46:47], v[46:47], v[54:55]
    v_cvt_pk_bf16_f32 v164, v40, v41
    v_cvt_pk_bf16_f32 v165, v42, v43
    v_cvt_pk_bf16_f32 v166, v44, v45
    v_cvt_pk_bf16_f32 v167, v46, v47
    buffer_store_dwordx4 v[164:167], v182, s[28:31], s38 offen offset:3072 sc1
    s_lshl_b32 s19, s32, 11
    s_lshl_b32 s52, s33, 7
    s_add_u32 s19, s19, s52
    s_add_u32 s19, s19, 229376

    s_branch L_g1_end_38
L_g1_post_out_26:
    s_mov_b32 s54, 0
L_nonce_spin_1028:
    v_readfirstlane_b32 s62, v151
    s_add_u32 s54, s54, 1
    s_cmp_lg_u32 s62, 0
    s_cbranch_scc1 L_nonce_done_1029
    s_cmp_ge_u32 s54, 0x40000
    s_cbranch_scc1 L_nonce_done_1029
    s_sleep 1

    v_mov_b32 v2, 0
    buffer_load_dword v151, v2, s[56:59], 0 offen sc1
    s_waitcnt vmcnt(0)
    s_branch L_nonce_spin_1028

L_nonce_done_1029:
    v_mov_b32 v2, 161280
    v_mov_b32 v3, s62
    ds_write_b32 v2, v3
    s_waitcnt lgkmcnt(0)

    s_lshl_b32 s52, s2, 7
    s_add_u32 s52, s52, 131072

    v_mov_b32 v2, s52
    v_mov_b32 v3, s62
    s_mov_b64 exec, 1
    buffer_store_dword v3, v2, s[28:31], 0 offen sc1
    s_mov_b64 exec, -1

    s_branch L_g1_post_back_27
L_g1_kvf_out_28:
    s_and_b32 s52, s2, 7
    s_lshl_b32 s52, s52, 12
    s_lshr_b32 s53, s2, 3
    s_lshl_b32 s53, s53, 7
    s_add_u32 s52, s52, s53
    s_add_u32 s52, s52, 196608

    v_mov_b32 v2, s52
    v_mov_b32 v3, s62
    s_mov_b64 exec, 1
    buffer_store_dword v3, v2, s[28:31], 0 offen sc1
    s_mov_b64 exec, -1

    s_branch L_g1_kvf_back_29
L_g1_poll1_out_30:
    buffer_load_dword v149, v150, s[28:31], 0 offen sc1
    s_branch L_g1_poll1_back_31
L_g1_pads_out_32:
    s_lshr_b32 s52, s18, 1
    s_and_b32 s53, s18, 1
    s_mul_i32 s54, s52, 12928
    s_add_u32 s54, s54, 131072
    v_lshl_add_u32 v3, v1, 4, s54
    v_mov_b32 v4, 0
    v_mov_b32 v5, 0
    v_mov_b32 v6, 0
    v_mov_b32 v7, 0
    s_cmp_eq_u32 s53, 1
    s_cbranch_scc1 L_cv_odd_4034
    s_mov_b64 exec, 3
    ds_write_b128 v3, v[4:7]
    s_mov_b64 exec, 0x3fffffff
    ds_write_b128 v3, v[4:7] offset:12416
    s_mov_b64 exec, -1
    s_branch L_cv_pad_4035

L_cv_odd_4034:
    s_lshl_b32 s52, s16, 16
    v_cmp_eq_u32 vcc, 1, v1
    v_mov_b32 v7, s52
    s_nop 0
    v_cndmask_b32 v7, 0, v7, vcc
    s_mov_b64 exec, 3
    ds_write_b128 v3, v[4:7] offset:4160
    s_mov_b64 exec, -1

L_cv_pad_4035:
    s_branch L_g1_pads_back_33
L_g1_req1_out_34:
    v_cmp_ne_u32 vcc, s62, v149
    s_bitcmp1_b32 s63, 0
    s_cbranch_scc1 L_rq_op_5036
    s_cmp_lg_u32 vcc_lo, 0
    s_cbranch_scc1 L_rq_op_5036
    s_or_b32 s63, s63, 1

    s_mov_b32 m0, 157184
    s_lshl_b32 s52, s32, 10
    s_add_u32 s52, s52, 0
    v_lshlrev_b32 v2, 4, v1
    buffer_load_dwordx4 v2, s[28:31], s52 offen sc1 lds
    s_mov_b32 m0, 158208
    s_nop 0
    buffer_load_dwordx4 v148, s[28:31], 0 offen sc1 lds

L_rq_op_5036:
    s_bitcmp1_b32 s63, 1
    s_cbranch_scc1 L_rq_u_5037
    s_cmp_lg_u32 vcc_hi, 0
    s_cbranch_scc1 L_rq_u_5037
    s_or_b32 s63, s63, 2

    s_lshl_b32 s52, s2, 13
    s_add_u32 s52, s52, 1048576
    v_lshlrev_b32 v2, 4, v1

    s_mov_b32 m0, 139392
    s_add_u32 s53, s52, 0
    buffer_load_dwordx4 v2, s[28:31], s53 offen offset:0 sc1 lds
    buffer_load_dwordx4 v2, s[28:31], s53 offen offset:1024 sc1 lds
    buffer_load_dwordx4 v2, s[28:31], s53 offen offset:2048 sc1 lds
    buffer_load_dwordx4 v2, s[28:31], s53 offen offset:3072 sc1 lds
    s_mov_b32 m0, 152320
    s_add_u32 s53, s52, 4096
    buffer_load_dwordx4 v2, s[28:31], s53 offen offset:0 sc1 lds
    buffer_load_dwordx4 v2, s[28:31], s53 offen offset:1024 sc1 lds
    buffer_load_dwordx4 v2, s[28:31], s53 offen offset:2048 sc1 lds
    buffer_load_dwordx4 v2, s[28:31], s53 offen offset:3072 sc1 lds
L_rq_u_5037:
    s_cmp_eq_u32 s63, 3
    s_cbranch_scc1 L_rq_e_5038

    buffer_load_dword v149, v150, s[28:31], 0 offen sc1
L_rq_e_5038:
    s_branch L_g1_req1_back_35
L_g1_fin_out_36:
    s_mov_b32 s54, 0
L_fin_spin_6038:
    s_cmp_eq_u32 s63, 3
    s_cbranch_scc1 L_fin_e_6039
    s_cmp_ge_u32 s54, 0x40000
    s_cbranch_scc1 L_fin_e_6039
    s_add_u32 s54, s54, 1
    s_waitcnt vmcnt(0)

    v_cmp_ne_u32 vcc, s62, v149
    s_bitcmp1_b32 s63, 0
    s_cbranch_scc1 L_rq_op_6040
    s_cmp_lg_u32 vcc_lo, 0
    s_cbranch_scc1 L_rq_op_6040
    s_or_b32 s63, s63, 1

    s_mov_b32 m0, 157184
    s_lshl_b32 s52, s32, 10
    s_add_u32 s52, s52, 0
    v_lshlrev_b32 v2, 4, v1
    buffer_load_dwordx4 v2, s[28:31], s52 offen sc1 lds
    s_mov_b32 m0, 158208
    s_nop 0
    buffer_load_dwordx4 v148, s[28:31], 0 offen sc1 lds

L_rq_op_6040:
    s_bitcmp1_b32 s63, 1
    s_cbranch_scc1 L_rq_u_6041
    s_cmp_lg_u32 vcc_hi, 0
    s_cbranch_scc1 L_rq_u_6041
    s_or_b32 s63, s63, 2

    s_lshl_b32 s52, s2, 13
    s_add_u32 s52, s52, 1048576
    v_lshlrev_b32 v2, 4, v1

    s_mov_b32 m0, 139392
    s_add_u32 s53, s52, 0
    buffer_load_dwordx4 v2, s[28:31], s53 offen offset:0 sc1 lds
    buffer_load_dwordx4 v2, s[28:31], s53 offen offset:1024 sc1 lds
    buffer_load_dwordx4 v2, s[28:31], s53 offen offset:2048 sc1 lds
    buffer_load_dwordx4 v2, s[28:31], s53 offen offset:3072 sc1 lds
    s_mov_b32 m0, 152320
    s_add_u32 s53, s52, 4096
    buffer_load_dwordx4 v2, s[28:31], s53 offen offset:0 sc1 lds
    buffer_load_dwordx4 v2, s[28:31], s53 offen offset:1024 sc1 lds
    buffer_load_dwordx4 v2, s[28:31], s53 offen offset:2048 sc1 lds
    buffer_load_dwordx4 v2, s[28:31], s53 offen offset:3072 sc1 lds
L_rq_u_6041:
    s_cmp_eq_u32 s63, 3
    s_cbranch_scc1 L_rq_e_6042

    buffer_load_dword v149, v150, s[28:31], 0 offen sc1
L_rq_e_6042:
    s_branch L_fin_spin_6038
L_fin_e_6039:
    s_branch L_g1_fin_back_37
L_g1_end_38:
L_fr_back_3:

    v_mov_b32 v2, 161280
    ds_read_b32 v2, v2
    s_and_b32 s52, s2, 7
    s_lshr_b32 s53, s2, 3
    s_lshr_b32 s35, s53, 3
    s_lshl_b32 s52, s52, 2
    s_add_u32 s35, s35, s52
    s_and_b32 s34, s53, 7
    s_mov_b32 s24, s48
    s_mov_b32 s25, s49
    s_mov_b32 s26, 1835008
    s_mov_b32 s27, 0x00020000
    s_waitcnt lgkmcnt(0)
    v_readfirstlane_b32 s62, v2

    s_mov_b32 s40, s8
    s_mov_b32 s41, s9
    s_mov_b32 s42, 2097152
    s_mov_b32 s43, 0x00020000
    s_cmp_ge_u32 s18, 4
    s_cbranch_scc1 L_bk_loader_39

    s_lshr_b32 s52, s18, 1
    s_and_b32 s53, s18, 1
    s_mul_i32 s60, s52, 12928
    s_add_u32 s60, s60, 131072
    v_and_b32 v2, 15, v1
    v_lshrrev_b32 v3, 4, v1
    v_lshlrev_b32 v4, 3, v3
    v_sub_u32 v4, v2, v4
    v_add_u32 v4, 9, v4
    v_lshlrev_b32 v4, 1, v4
    v_and_b32 v5, 1, v2
    v_cmp_eq_u32 vcc, 0, v5
    v_mov_b32 v6, 4158
    s_lshl_b32 s61, s53, 8
    v_cndmask_b32 v6, 0, v6, vcc
    s_add_u32 s63, s60, 32
    s_add_u32 s63, s63, s61
    v_add3_u32 v168, v4, v6, s63
    v_add_u32 v169, 1024, v168
    v_add_u32 v170, 2048, v168
    v_add_u32 v171, 3072, v168
    v_lshlrev_b32 v4, 5, v2
    v_lshl_add_u32 v4, v3, 4, v4
    s_add_u32 s63, s60, 8848
    s_add_u32 s63, s63, s61
    v_sub_u32 v172, s63, v4

    ds_read_b128 v[72:75], v172 offset:3584
    ds_read2_b32 v[40:41], v168 offset0:0 offset1:1
    ds_read2_b32 v[42:43], v168 offset0:2 offset1:3
    ds_read_b128 v[76:79], v172 offset:3072
    ds_read2_b32 v[44:45], v168 offset0:128 offset1:129
    ds_read2_b32 v[46:47], v168 offset0:130 offset1:131
    ds_read_b128 v[80:83], v172 offset:2560
    ds_read2_b32 v[48:49], v169 offset0:0 offset1:1
    ds_read2_b32 v[50:51], v169 offset0:2 offset1:3
    ds_read_b128 v[84:87], v172 offset:2048
    ds_read2_b32 v[52:53], v169 offset0:128 offset1:129
    ds_read2_b32 v[54:55], v169 offset0:130 offset1:131
    ds_read_b128 v[88:91], v172 offset:1536
    ds_read2_b32 v[56:57], v170 offset0:0 offset1:1
    ds_read2_b32 v[58:59], v170 offset0:2 offset1:3
    ds_read_b128 v[92:95], v172 offset:1024
    ds_read2_b32 v[60:61], v170 offset0:128 offset1:129
    ds_read2_b32 v[62:63], v170 offset0:130 offset1:131
    ds_read_b128 v[96:99], v172 offset:512
    ds_read2_b32 v[64:65], v171 offset0:0 offset1:1
    ds_read2_b32 v[66:67], v171 offset0:2 offset1:3
    ds_read_b128 v[100:103], v172 offset:0
    ds_read2_b32 v[68:69], v171 offset0:128 offset1:129
    ds_read2_b32 v[70:71], v171 offset0:130 offset1:131
    v_mov_b32 v8, 0
    v_mov_b32 v9, 0
    v_mov_b32 v10, 0
    v_mov_b32 v11, 0
    v_mov_b32 v12, 0
    v_mov_b32 v13, 0
    v_mov_b32 v14, 0
    v_mov_b32 v15, 0
    v_mov_b32 v16, 0
    v_mov_b32 v17, 0
    v_mov_b32 v18, 0
    v_mov_b32 v19, 0
    v_mov_b32 v20, 0
    v_mov_b32 v21, 0
    v_mov_b32 v22, 0
    v_mov_b32 v23, 0
    v_mov_b32 v24, 0
    v_mov_b32 v25, 0
    v_mov_b32 v26, 0
    v_mov_b32 v27, 0
    v_mov_b32 v28, 0
    v_mov_b32 v29, 0
    v_mov_b32 v30, 0
    v_mov_b32 v31, 0
    v_mov_b32 v32, 0
    v_mov_b32 v33, 0
    v_mov_b32 v34, 0
    v_mov_b32 v35, 0
    v_mov_b32 v36, 0
    v_mov_b32 v37, 0
    v_mov_b32 v38, 0
    v_mov_b32 v39, 0
    s_mov_b32 s61, 0
L_cv_loop_41:
    s_waitcnt lgkmcnt(0)
    v_mfma_f32_16x16x32_bf16 v[8:11], v[40:43], v[72:75], v[8:11]
    v_add_u32 v168, 64, v168
    v_mfma_f32_16x16x32_bf16 v[12:15], v[40:43], v[76:79], v[12:15]
    v_add_u32 v169, 64, v169
    v_mfma_f32_16x16x32_bf16 v[12:15], v[44:47], v[72:75], v[12:15]
    v_add_u32 v170, 64, v170
    v_mfma_f32_16x16x32_bf16 v[16:19], v[40:43], v[80:83], v[16:19]
    v_add_u32 v171, 64, v171
    v_mfma_f32_16x16x32_bf16 v[16:19], v[44:47], v[76:79], v[16:19]
    v_add_u32 v172, 64, v172
    v_mfma_f32_16x16x32_bf16 v[16:19], v[48:51], v[72:75], v[16:19]
    ds_read_b128 v[136:139], v172 offset:3584
    v_mfma_f32_16x16x32_bf16 v[20:23], v[40:43], v[84:87], v[20:23]
    ds_read2_b32 v[104:105], v168 offset0:0 offset1:1
    v_mfma_f32_16x16x32_bf16 v[20:23], v[44:47], v[80:83], v[20:23]
    ds_read2_b32 v[106:107], v168 offset0:2 offset1:3
    v_mfma_f32_16x16x32_bf16 v[20:23], v[48:51], v[76:79], v[20:23]
    ds_read_b128 v[140:143], v172 offset:3072
    v_mfma_f32_16x16x32_bf16 v[20:23], v[52:55], v[72:75], v[20:23]
    ds_read2_b32 v[108:109], v168 offset0:128 offset1:129
    v_mfma_f32_16x16x32_bf16 v[24:27], v[40:43], v[88:91], v[24:27]
    ds_read2_b32 v[110:111], v168 offset0:130 offset1:131
    v_mfma_f32_16x16x32_bf16 v[24:27], v[44:47], v[84:87], v[24:27]
    ds_read_b128 v[144:147], v172 offset:2560
    v_mfma_f32_16x16x32_bf16 v[24:27], v[48:51], v[80:83], v[24:27]
    ds_read2_b32 v[112:113], v169 offset0:0 offset1:1
    v_mfma_f32_16x16x32_bf16 v[24:27], v[52:55], v[76:79], v[24:27]
    ds_read2_b32 v[114:115], v169 offset0:2 offset1:3
    v_mfma_f32_16x16x32_bf16 v[24:27], v[56:59], v[72:75], v[24:27]
    ds_read_b128 v[148:151], v172 offset:2048
    v_mfma_f32_16x16x32_bf16 v[28:31], v[40:43], v[92:95], v[28:31]
    ds_read2_b32 v[116:117], v169 offset0:128 offset1:129
    v_mfma_f32_16x16x32_bf16 v[28:31], v[44:47], v[88:91], v[28:31]
    ds_read2_b32 v[118:119], v169 offset0:130 offset1:131
    v_mfma_f32_16x16x32_bf16 v[28:31], v[48:51], v[84:87], v[28:31]
    ds_read_b128 v[152:155], v172 offset:1536
    v_mfma_f32_16x16x32_bf16 v[28:31], v[52:55], v[80:83], v[28:31]
    ds_read2_b32 v[120:121], v170 offset0:0 offset1:1
    v_mfma_f32_16x16x32_bf16 v[28:31], v[56:59], v[76:79], v[28:31]
    ds_read2_b32 v[122:123], v170 offset0:2 offset1:3
    v_mfma_f32_16x16x32_bf16 v[28:31], v[60:63], v[72:75], v[28:31]
    ds_read_b128 v[156:159], v172 offset:1024
    v_mfma_f32_16x16x32_bf16 v[32:35], v[40:43], v[96:99], v[32:35]
    ds_read2_b32 v[124:125], v170 offset0:128 offset1:129
    v_mfma_f32_16x16x32_bf16 v[32:35], v[44:47], v[92:95], v[32:35]
    ds_read2_b32 v[126:127], v170 offset0:130 offset1:131
    v_mfma_f32_16x16x32_bf16 v[32:35], v[48:51], v[88:91], v[32:35]
    ds_read_b128 v[160:163], v172 offset:512
    v_mfma_f32_16x16x32_bf16 v[32:35], v[52:55], v[84:87], v[32:35]
    ds_read2_b32 v[128:129], v171 offset0:0 offset1:1
    v_mfma_f32_16x16x32_bf16 v[32:35], v[56:59], v[80:83], v[32:35]
    ds_read2_b32 v[130:131], v171 offset0:2 offset1:3
    v_mfma_f32_16x16x32_bf16 v[32:35], v[60:63], v[76:79], v[32:35]
    ds_read_b128 v[164:167], v172 offset:0
    v_mfma_f32_16x16x32_bf16 v[32:35], v[64:67], v[72:75], v[32:35]
    ds_read2_b32 v[132:133], v171 offset0:128 offset1:129
    v_mfma_f32_16x16x32_bf16 v[36:39], v[40:43], v[100:103], v[36:39]
    ds_read2_b32 v[134:135], v171 offset0:130 offset1:131
    v_mfma_f32_16x16x32_bf16 v[36:39], v[44:47], v[96:99], v[36:39]
    v_mfma_f32_16x16x32_bf16 v[36:39], v[48:51], v[92:95], v[36:39]
    v_mfma_f32_16x16x32_bf16 v[36:39], v[52:55], v[88:91], v[36:39]
    v_mfma_f32_16x16x32_bf16 v[36:39], v[56:59], v[84:87], v[36:39]
    v_mfma_f32_16x16x32_bf16 v[36:39], v[60:63], v[80:83], v[36:39]
    v_mfma_f32_16x16x32_bf16 v[36:39], v[64:67], v[76:79], v[36:39]
    v_mfma_f32_16x16x32_bf16 v[36:39], v[68:71], v[72:75], v[36:39]
    s_waitcnt lgkmcnt(0)
    s_cmp_eq_u32 s61, 1
    s_cbranch_scc1 L_cv_done_42
    s_mov_b32 s61, 1

    v_mfma_f32_16x16x32_bf16 v[8:11], v[104:107], v[136:139], v[8:11]
    v_add_u32 v168, 64, v168
    v_mfma_f32_16x16x32_bf16 v[12:15], v[104:107], v[140:143], v[12:15]
    v_add_u32 v169, 64, v169
    v_mfma_f32_16x16x32_bf16 v[12:15], v[108:111], v[136:139], v[12:15]
    v_add_u32 v170, 64, v170
    v_mfma_f32_16x16x32_bf16 v[16:19], v[104:107], v[144:147], v[16:19]
    v_add_u32 v171, 64, v171
    v_mfma_f32_16x16x32_bf16 v[16:19], v[108:111], v[140:143], v[16:19]
    v_add_u32 v172, 64, v172
    v_mfma_f32_16x16x32_bf16 v[16:19], v[112:115], v[136:139], v[16:19]
    ds_read_b128 v[72:75], v172 offset:3584
    v_mfma_f32_16x16x32_bf16 v[20:23], v[104:107], v[148:151], v[20:23]
    ds_read2_b32 v[40:41], v168 offset0:0 offset1:1
    v_mfma_f32_16x16x32_bf16 v[20:23], v[108:111], v[144:147], v[20:23]
    ds_read2_b32 v[42:43], v168 offset0:2 offset1:3
    v_mfma_f32_16x16x32_bf16 v[20:23], v[112:115], v[140:143], v[20:23]
    ds_read_b128 v[76:79], v172 offset:3072
    v_mfma_f32_16x16x32_bf16 v[20:23], v[116:119], v[136:139], v[20:23]
    ds_read2_b32 v[44:45], v168 offset0:128 offset1:129
    v_mfma_f32_16x16x32_bf16 v[24:27], v[104:107], v[152:155], v[24:27]
    ds_read2_b32 v[46:47], v168 offset0:130 offset1:131
    v_mfma_f32_16x16x32_bf16 v[24:27], v[108:111], v[148:151], v[24:27]
    ds_read_b128 v[80:83], v172 offset:2560
    v_mfma_f32_16x16x32_bf16 v[24:27], v[112:115], v[144:147], v[24:27]
    ds_read2_b32 v[48:49], v169 offset0:0 offset1:1
    v_mfma_f32_16x16x32_bf16 v[24:27], v[116:119], v[140:143], v[24:27]
    ds_read2_b32 v[50:51], v169 offset0:2 offset1:3
    v_mfma_f32_16x16x32_bf16 v[24:27], v[120:123], v[136:139], v[24:27]
    ds_read_b128 v[84:87], v172 offset:2048
    v_mfma_f32_16x16x32_bf16 v[28:31], v[104:107], v[156:159], v[28:31]
    ds_read2_b32 v[52:53], v169 offset0:128 offset1:129
    v_mfma_f32_16x16x32_bf16 v[28:31], v[108:111], v[152:155], v[28:31]
    ds_read2_b32 v[54:55], v169 offset0:130 offset1:131
    v_mfma_f32_16x16x32_bf16 v[28:31], v[112:115], v[148:151], v[28:31]
    ds_read_b128 v[88:91], v172 offset:1536
    v_mfma_f32_16x16x32_bf16 v[28:31], v[116:119], v[144:147], v[28:31]
    ds_read2_b32 v[56:57], v170 offset0:0 offset1:1
    v_mfma_f32_16x16x32_bf16 v[28:31], v[120:123], v[140:143], v[28:31]
    ds_read2_b32 v[58:59], v170 offset0:2 offset1:3
    v_mfma_f32_16x16x32_bf16 v[28:31], v[124:127], v[136:139], v[28:31]
    ds_read_b128 v[92:95], v172 offset:1024
    v_mfma_f32_16x16x32_bf16 v[32:35], v[104:107], v[160:163], v[32:35]
    ds_read2_b32 v[60:61], v170 offset0:128 offset1:129
    v_mfma_f32_16x16x32_bf16 v[32:35], v[108:111], v[156:159], v[32:35]
    ds_read2_b32 v[62:63], v170 offset0:130 offset1:131
    v_mfma_f32_16x16x32_bf16 v[32:35], v[112:115], v[152:155], v[32:35]
    ds_read_b128 v[96:99], v172 offset:512
    v_mfma_f32_16x16x32_bf16 v[32:35], v[116:119], v[148:151], v[32:35]
    ds_read2_b32 v[64:65], v171 offset0:0 offset1:1
    v_mfma_f32_16x16x32_bf16 v[32:35], v[120:123], v[144:147], v[32:35]
    ds_read2_b32 v[66:67], v171 offset0:2 offset1:3
    v_mfma_f32_16x16x32_bf16 v[32:35], v[124:127], v[140:143], v[32:35]
    ds_read_b128 v[100:103], v172 offset:0
    v_mfma_f32_16x16x32_bf16 v[32:35], v[128:131], v[136:139], v[32:35]
    ds_read2_b32 v[68:69], v171 offset0:128 offset1:129
    v_mfma_f32_16x16x32_bf16 v[36:39], v[104:107], v[164:167], v[36:39]
    ds_read2_b32 v[70:71], v171 offset0:130 offset1:131
    v_mfma_f32_16x16x32_bf16 v[36:39], v[108:111], v[160:163], v[36:39]
    v_mfma_f32_16x16x32_bf16 v[36:39], v[112:115], v[156:159], v[36:39]
    v_mfma_f32_16x16x32_bf16 v[36:39], v[116:119], v[152:155], v[36:39]
    v_mfma_f32_16x16x32_bf16 v[36:39], v[120:123], v[148:151], v[36:39]
    v_mfma_f32_16x16x32_bf16 v[36:39], v[124:127], v[144:147], v[36:39]
    v_mfma_f32_16x16x32_bf16 v[36:39], v[128:131], v[140:143], v[36:39]
    v_mfma_f32_16x16x32_bf16 v[36:39], v[132:135], v[136:139], v[36:39]
    v_mov_b32 v2, 161288
    v_mov_b32 v3, 1
    s_waitcnt vmcnt(0)
    ds_add_u32 v2, v3

    s_branch L_cv_loop_41
L_cv_done_42:
    v_mfma_f32_16x16x32_bf16 v[8:11], v[104:107], v[136:139], v[8:11]
    v_mfma_f32_16x16x32_bf16 v[12:15], v[104:107], v[140:143], v[12:15]
    v_mfma_f32_16x16x32_bf16 v[12:15], v[108:111], v[136:139], v[12:15]
    v_mfma_f32_16x16x32_bf16 v[16:19], v[104:107], v[144:147], v[16:19]
    v_mfma_f32_16x16x32_bf16 v[16:19], v[108:111], v[140:143], v[16:19]
    v_mfma_f32_16x16x32_bf16 v[16:19], v[112:115], v[136:139], v[16:19]
    v_mfma_f32_16x16x32_bf16 v[20:23], v[104:107], v[148:151], v[20:23]
    v_mfma_f32_16x16x32_bf16 v[20:23], v[108:111], v[144:147], v[20:23]
    v_mfma_f32_16x16x32_bf16 v[20:23], v[112:115], v[140:143], v[20:23]
    v_mfma_f32_16x16x32_bf16 v[20:23], v[116:119], v[136:139], v[20:23]
    v_mfma_f32_16x16x32_bf16 v[24:27], v[104:107], v[152:155], v[24:27]
    v_mfma_f32_16x16x32_bf16 v[24:27], v[108:111], v[148:151], v[24:27]
    v_mfma_f32_16x16x32_bf16 v[24:27], v[112:115], v[144:147], v[24:27]
    v_mfma_f32_16x16x32_bf16 v[24:27], v[116:119], v[140:143], v[24:27]
    v_mfma_f32_16x16x32_bf16 v[24:27], v[120:123], v[136:139], v[24:27]
    v_mfma_f32_16x16x32_bf16 v[28:31], v[104:107], v[156:159], v[28:31]
    v_mfma_f32_16x16x32_bf16 v[28:31], v[108:111], v[152:155], v[28:31]
    v_mfma_f32_16x16x32_bf16 v[28:31], v[112:115], v[148:151], v[28:31]
    v_mfma_f32_16x16x32_bf16 v[28:31], v[116:119], v[144:147], v[28:31]
    v_mfma_f32_16x16x32_bf16 v[28:31], v[120:123], v[140:143], v[28:31]
    v_mfma_f32_16x16x32_bf16 v[28:31], v[124:127], v[136:139], v[28:31]
    v_mfma_f32_16x16x32_bf16 v[32:35], v[104:107], v[160:163], v[32:35]
    v_mfma_f32_16x16x32_bf16 v[32:35], v[108:111], v[156:159], v[32:35]
    v_mfma_f32_16x16x32_bf16 v[32:35], v[112:115], v[152:155], v[32:35]
    v_mfma_f32_16x16x32_bf16 v[32:35], v[116:119], v[148:151], v[32:35]
    v_mfma_f32_16x16x32_bf16 v[32:35], v[120:123], v[144:147], v[32:35]
    v_mfma_f32_16x16x32_bf16 v[32:35], v[124:127], v[140:143], v[32:35]
    v_mfma_f32_16x16x32_bf16 v[32:35], v[128:131], v[136:139], v[32:35]
    v_mfma_f32_16x16x32_bf16 v[36:39], v[104:107], v[164:167], v[36:39]
    v_mfma_f32_16x16x32_bf16 v[36:39], v[108:111], v[160:163], v[36:39]
    v_mfma_f32_16x16x32_bf16 v[36:39], v[112:115], v[156:159], v[36:39]
    v_mfma_f32_16x16x32_bf16 v[36:39], v[116:119], v[152:155], v[36:39]
    v_mfma_f32_16x16x32_bf16 v[36:39], v[120:123], v[148:151], v[36:39]
    v_mfma_f32_16x16x32_bf16 v[36:39], v[124:127], v[144:147], v[36:39]
    v_mfma_f32_16x16x32_bf16 v[36:39], v[128:131], v[140:143], v[36:39]
    v_mfma_f32_16x16x32_bf16 v[36:39], v[132:135], v[136:139], v[36:39]
    s_lshl_b32 s61, s18, 13
    s_add_u32 s61, s61, 98304
    v_lshlrev_b32 v2, 4, v1
    v_add_u32 v3, s61, v2
    v_and_b32 v4, 15, v1
    v_lshrrev_b32 v5, 4, v1
    v_lshlrev_b32 v6, 5, v4
    v_lshl_add_u32 v6, v5, 3, v6
    s_lshl_b32 s63, s18, 10
    s_sub_u32 s63, 142968, s63
    v_sub_u32 v7, s63, v6
    ds_read_b64 v[40:41], v7 offset:512
    ds_read_b64 v[42:43], v7
    ds_read_b64 v[44:45], v7 offset:13440
    ds_read_b64 v[46:47], v7 offset:12928
    s_nop 4

    ds_write_b128 v3, v[8:11] offset:0
    ds_write_b128 v3, v[12:15] offset:1024
    ds_write_b128 v3, v[16:19] offset:2048
    ds_write_b128 v3, v[20:23] offset:3072
    ds_write_b128 v3, v[24:27] offset:4096
    ds_write_b128 v3, v[28:31] offset:5120
    ds_write_b128 v3, v[32:35] offset:6144
    ds_write_b128 v3, v[36:39] offset:7168
    s_and_b32 s52, s18, 1
    s_lshr_b32 s53, s18, 1
    v_and_b32 v5, 31, v1
    v_lshrrev_b32 v6, 5, v1
    s_lshl_b32 s54, s35, 6
    s_lshl_b32 s55, s52, 5
    s_add_u32 s54, s54, s55
    v_add_u32 v2, s54, v5
    s_lshl_b32 s54, s34, 6
    s_lshl_b32 s55, s53, 5
    s_add_u32 s54, s54, s55
    v_lshl_add_u32 v3, v6, 4, s54
    v_lshlrev_b32 v4, 10, v2
    v_lshl_add_u32 v188, v3, 1, v4
    buffer_load_dwordx4 v[176:179], v188, s[20:23], 0 offen
    buffer_load_dwordx4 v[180:183], v188, s[20:23], 0 offen offset:16
    v_lshlrev_b32 v4, 3, v2
    buffer_load_dwordx2 v[184:185], v4, s[28:31], 0 offen offset:0 sc1
    v_lshlrev_b32 v4, 12, v3
    v_lshl_add_u32 v189, v2, 2, v4
    s_lshl_b32 s54, s52, 13
    v_lshl_add_u32 v186, v1, 4, s54
    v_bfe_u32 v2, v1, 2, 2
    v_bfe_u32 v3, v1, 4, 1
    v_and_b32 v4, 1, v1
    v_lshl_add_u32 v3, v4, 1, v3
    v_lshrrev_b32 v4, 1, v2
    v_xor_b32 v4, s53, v4
    v_lshl_add_u32 v3, v4, 2, v3
    v_bfe_u32 v4, v1, 1, 1
    v_lshlrev_b32 v4, 3, v4
    v_lshl_add_u32 v3, v3, 4, v4
    v_lshl_add_u32 v2, v6, 2, v2
    v_lshl_add_u32 v3, v2, 7, v3
    v_add_u32 v187, 16384, v3

    v_lshlrev_b32 v2, 4, v1
    v_and_b32 v4, 15, v1
    v_lshrrev_b32 v5, 4, v1

    s_lshl_b32 s61, s18, 11
    s_add_u32 s61, s61, 98304
    v_add_u32 v3, s61, v2
    s_waitcnt lgkmcnt(0)

    v_mov_b32 v48, 161292
    v_mov_b32 v49, 1
    ds_add_u32 v48, v49
    s_mov_b32 s63, 0

L_cv_xspin_43:
    ds_read_b32 v49, v48
    s_add_u32 s63, s63, 1
    s_waitcnt lgkmcnt(0)
    v_readfirstlane_b32 s61, v49
    s_cmp_ge_u32 s61, 256
    s_cbranch_scc1 L_cv_xdone_44
    s_cmp_lt_u32 s63, 0x400000
    s_cbranch_scc1 L_cv_xspin_43

L_cv_xdone_44:
    ds_read_b128 v[48:51], v3 offset:0
    ds_read_b128 v[52:55], v3 offset:1024
    ds_read_b128 v[56:59], v3 offset:8192
    ds_read_b128 v[60:63], v3 offset:9216
    ds_read_b128 v[64:67], v3 offset:16384
    ds_read_b128 v[68:71], v3 offset:17408
    ds_read_b128 v[72:75], v3 offset:24576
    ds_read_b128 v[76:79], v3 offset:25600
    s_lshl_b32 s56, s17, 16
    s_and_b32 s57, s17, 0xffff0000
    v_lshlrev_b32 v6, 6, v4
    v_lshl_add_u32 v6, v5, 4, v6
    s_lshl_b32 s61, s2, 13
    s_lshl_b32 s53, s18, 11
    s_add_u32 s61, s61, s53
    s_add_u32 s61, s61, 12582912
    s_waitcnt lgkmcnt(0)

    v_add_f32 v80, v48, v56
    v_add_f32 v81, v49, v57
    v_add_f32 v82, v50, v58
    v_add_f32 v83, v51, v59
    v_and_b32 v84, 0xffff0000, v41
    v_lshlrev_b32 v85, 16, v41
    v_and_b32 v86, 0xffff0000, v40
    v_lshlrev_b32 v87, 16, v40
    v_fmac_f32 v80, s56, v84
    v_fmac_f32 v81, s56, v85
    v_fmac_f32 v82, s56, v86
    v_fmac_f32 v83, s56, v87
    v_add_f32 v88, v64, v72
    v_add_f32 v89, v65, v73
    v_add_f32 v90, v66, v74
    v_add_f32 v91, v67, v75
    v_and_b32 v92, 0xffff0000, v45
    v_lshlrev_b32 v93, 16, v45
    v_and_b32 v94, 0xffff0000, v44
    v_lshlrev_b32 v95, 16, v44
    v_fmac_f32 v88, s57, v92
    v_fmac_f32 v89, s57, v93
    v_fmac_f32 v90, s57, v94
    v_fmac_f32 v91, s57, v95
    v_cvt_pk_bf16_f32 v96, v80, v88
    v_cvt_pk_bf16_f32 v97, v81, v89
    v_cvt_pk_bf16_f32 v98, v82, v90
    v_cvt_pk_bf16_f32 v99, v83, v91
    buffer_store_dwordx4 v[96:99], v6, s[28:31], s61 offen offset:0 sc1
    v_add_f32 v80, v52, v60
    v_add_f32 v81, v53, v61
    v_add_f32 v82, v54, v62
    v_add_f32 v83, v55, v63
    v_and_b32 v84, 0xffff0000, v43
    v_lshlrev_b32 v85, 16, v43
    v_and_b32 v86, 0xffff0000, v42
    v_lshlrev_b32 v87, 16, v42
    v_fmac_f32 v80, s56, v84
    v_fmac_f32 v81, s56, v85
    v_fmac_f32 v82, s56, v86
    v_fmac_f32 v83, s56, v87
    v_add_f32 v88, v68, v76
    v_add_f32 v89, v69, v77
    v_add_f32 v90, v70, v78
    v_add_f32 v91, v71, v79
    v_and_b32 v92, 0xffff0000, v47
    v_lshlrev_b32 v93, 16, v47
    v_and_b32 v94, 0xffff0000, v46
    v_lshlrev_b32 v95, 16, v46
    v_fmac_f32 v88, s57, v92
    v_fmac_f32 v89, s57, v93
    v_fmac_f32 v90, s57, v94
    v_fmac_f32 v91, s57, v95
    v_cvt_pk_bf16_f32 v100, v80, v88
    v_cvt_pk_bf16_f32 v101, v81, v89
    v_cvt_pk_bf16_f32 v102, v82, v90
    v_cvt_pk_bf16_f32 v103, v83, v91
    buffer_store_dwordx4 v[100:103], v6, s[28:31], s61 offen offset:1024 sc1
    v_mov_b32 v8, 0
    v_mov_b32 v9, 0
    v_mov_b32 v10, 0
    v_mov_b32 v11, 0
    v_mov_b32 v12, 0
    v_mov_b32 v13, 0
    v_mov_b32 v14, 0
    v_mov_b32 v15, 0
    v_mov_b32 v16, 0
    v_mov_b32 v17, 0
    v_mov_b32 v18, 0
    v_mov_b32 v19, 0
    v_mov_b32 v20, 0
    v_mov_b32 v21, 0
    v_mov_b32 v22, 0
    v_mov_b32 v23, 0
    s_mov_b32 s54, 0
    s_mov_b32 s55, 0
    s_mov_b32 s56, 32768
    s_mov_b32 s57, 0
    s_lshl_b32 s58, s34, 12
    s_add_u32 s58, s58, 262144
    v_and_b32 v190, 31, v1
    v_lshl_add_u32 v190, v190, 7, s58
    s_barrier

    ds_read_b128 v[24:27], v186 offset:0
    ds_read_b64_tr_b16 v[28:29], v187 offset:0
    ds_read_b64_tr_b16 v[30:31], v187 offset:1024
L_g2_loop_45:
    ds_read_b128 v[32:35], v186 offset:1024
    ds_read_b64_tr_b16 v[36:37], v187 offset:2048
    ds_read_b64_tr_b16 v[38:39], v187 offset:3072
    s_waitcnt lgkmcnt(3)
    v_mfma_f32_32x32x16_bf16 v[8:23], v[28:31], v[24:27], v[8:23]
    ds_read_b128 v[24:27], v186 offset:2048
    ds_read_b64_tr_b16 v[28:29], v187 offset:4096
    ds_read_b64_tr_b16 v[30:31], v187 offset:5120
    s_waitcnt lgkmcnt(3)
    v_mfma_f32_32x32x16_bf16 v[8:23], v[36:39], v[32:35], v[8:23]
    ds_read_b128 v[32:35], v186 offset:3072
    ds_read_b64_tr_b16 v[36:37], v187 offset:6144
    ds_read_b64_tr_b16 v[38:39], v187 offset:7168
    s_waitcnt lgkmcnt(3)
    v_mfma_f32_32x32x16_bf16 v[8:23], v[28:31], v[24:27], v[8:23]
    ds_read_b128 v[24:27], v186 offset:4096
    ds_read_b64_tr_b16 v[28:29], v187 offset:8192
    ds_read_b64_tr_b16 v[30:31], v187 offset:9216
    s_waitcnt lgkmcnt(3)
    v_mfma_f32_32x32x16_bf16 v[8:23], v[36:39], v[32:35], v[8:23]
    ds_read_b128 v[32:35], v186 offset:5120
    ds_read_b64_tr_b16 v[36:37], v187 offset:10240
    ds_read_b64_tr_b16 v[38:39], v187 offset:11264
    s_waitcnt lgkmcnt(3)
    v_mfma_f32_32x32x16_bf16 v[8:23], v[28:31], v[24:27], v[8:23]
    ds_read_b128 v[24:27], v186 offset:6144
    ds_read_b64_tr_b16 v[28:29], v187 offset:12288
    ds_read_b64_tr_b16 v[30:31], v187 offset:13312
    s_waitcnt lgkmcnt(3)
    v_mfma_f32_32x32x16_bf16 v[8:23], v[36:39], v[32:35], v[8:23]
    ds_read_b128 v[32:35], v186 offset:7168
    ds_read_b64_tr_b16 v[36:37], v187 offset:14336
    ds_read_b64_tr_b16 v[38:39], v187 offset:15360
    s_waitcnt lgkmcnt(3)
    v_mfma_f32_32x32x16_bf16 v[8:23], v[28:31], v[24:27], v[8:23]
    s_cmp_eq_u32 s54, 13
    s_cbranch_scc1 L_g2_last_46
    s_cmp_lg_u32 s54, 1
    s_cbranch_scc1 L_g2_nodrain_47
    s_waitcnt vmcnt(0)

L_g2_nodrain_47:
    s_cmp_lg_u32 s54, 9
    s_cbranch_scc1 L_g2_nopoll_48
    buffer_load_dword v191, v190, s[28:31], 0 offen sc1

L_g2_nopoll_48:
    s_cmp_lg_u32 s54, 11
    s_cbranch_scc1 L_g2_nochk_49
    s_waitcnt vmcnt(0)
    v_cmp_ne_u32 vcc, s62, v191
    s_nop 1
    s_cmp_eq_u64 vcc, 0
    s_cbranch_scc0 L_g2_nochk_49
    s_mov_b32 s57, 1

    s_mov_b32 s59, 12582912
    buffer_load_dword v112, v189, s[28:31], s59 offen sc1
    s_add_u32 s59, s59, 8192
    buffer_load_dword v113, v189, s[28:31], s59 offen sc1
    s_add_u32 s59, s59, 8192
    buffer_load_dword v114, v189, s[28:31], s59 offen sc1
    s_add_u32 s59, s59, 8192
    buffer_load_dword v115, v189, s[28:31], s59 offen sc1
    s_add_u32 s59, s59, 8192
    buffer_load_dword v116, v189, s[28:31], s59 offen sc1
    s_add_u32 s59, s59, 8192
    buffer_load_dword v117, v189, s[28:31], s59 offen sc1
    s_add_u32 s59, s59, 8192
    buffer_load_dword v118, v189, s[28:31], s59 offen sc1
    s_add_u32 s59, s59, 8192
    buffer_load_dword v119, v189, s[28:31], s59 offen sc1
L_g2_nochk_49:
    s_waitcnt lgkmcnt(0)
    s_barrier
    s_add_u32 s55, s55, 32768
    s_and_b32 s55, s55, 0x1ffff
    s_cmp_eq_u32 s55, 0
    s_cselect_b32 s59, 4294868992, s56
    s_add_u32 s54, s54, 1
    v_add_u32 v186, s59, v186
    v_add_u32 v187, s59, v187

    ds_read_b128 v[24:27], v186 offset:0
    ds_read_b64_tr_b16 v[28:29], v187 offset:0
    ds_read_b64_tr_b16 v[30:31], v187 offset:1024
    v_mfma_f32_32x32x16_bf16 v[8:23], v[36:39], v[32:35], v[8:23]
    s_branch L_g2_loop_45
L_g2_last_46:
    s_waitcnt lgkmcnt(0)
    v_mfma_f32_32x32x16_bf16 v[8:23], v[36:39], v[32:35], v[8:23]
    s_cmp_eq_u32 s57, 1
    s_cbranch_scc1 L_g2_got_50

    s_mov_b32 s63, 0
L_g2_y2f_spin_51:
    buffer_load_dword v191, v190, s[28:31], 0 offen sc1
    s_add_u32 s63, s63, 1
    s_waitcnt vmcnt(0)
    v_cmp_ne_u32 vcc, s62, v191
    s_nop 1
    s_cmp_eq_u64 vcc, 0
    s_cbranch_scc1 L_g2_y2f_done_52
    s_cmp_ge_u32 s63, 0x40000
    s_cbranch_scc1 L_g2_y2f_done_52
    s_sleep 4
    s_branch L_g2_y2f_spin_51

L_g2_y2f_done_52:
    s_mov_b32 s59, 12582912
    buffer_load_dword v112, v189, s[28:31], s59 offen sc1
    s_add_u32 s59, s59, 8192
    buffer_load_dword v113, v189, s[28:31], s59 offen sc1
    s_add_u32 s59, s59, 8192
    buffer_load_dword v114, v189, s[28:31], s59 offen sc1
    s_add_u32 s59, s59, 8192
    buffer_load_dword v115, v189, s[28:31], s59 offen sc1
    s_add_u32 s59, s59, 8192
    buffer_load_dword v116, v189, s[28:31], s59 offen sc1
    s_add_u32 s59, s59, 8192
    buffer_load_dword v117, v189, s[28:31], s59 offen sc1
    s_add_u32 s59, s59, 8192
    buffer_load_dword v118, v189, s[28:31], s59 offen sc1
    s_add_u32 s59, s59, 8192
    buffer_load_dword v119, v189, s[28:31], s59 offen sc1
L_g2_got_50:
    v_mov_b32 v40, 1.0
    v_mov_b32 v41, 1.0
    v_mov_b32 v42, 0xbfb8aa3b
    v_mov_b32 v43, 0xbfb8aa3b

    v_pk_mul_f32 v[24:25], v[8:9], v[42:43]
    v_pk_mul_f32 v[26:27], v[10:11], v[42:43]
    v_pk_mul_f32 v[28:29], v[12:13], v[42:43]
    v_pk_mul_f32 v[30:31], v[14:15], v[42:43]
    v_pk_mul_f32 v[32:33], v[16:17], v[42:43]
    v_pk_mul_f32 v[34:35], v[18:19], v[42:43]
    v_pk_mul_f32 v[36:37], v[20:21], v[42:43]
    v_pk_mul_f32 v[38:39], v[22:23], v[42:43]
    v_exp_f32 v24, v24
    v_exp_f32 v25, v25
    v_exp_f32 v26, v26
    v_exp_f32 v27, v27
    v_exp_f32 v28, v28
    v_exp_f32 v29, v29
    v_exp_f32 v30, v30
    v_exp_f32 v31, v31
    v_exp_f32 v32, v32
    v_exp_f32 v33, v33
    v_exp_f32 v34, v34
    v_exp_f32 v35, v35
    v_exp_f32 v36, v36
    v_exp_f32 v37, v37
    v_exp_f32 v38, v38
    v_exp_f32 v39, v39
    v_pk_add_f32 v[24:25], v[24:25], v[40:41]
    v_pk_add_f32 v[26:27], v[26:27], v[40:41]
    v_pk_add_f32 v[28:29], v[28:29], v[40:41]
    v_pk_add_f32 v[30:31], v[30:31], v[40:41]
    v_pk_add_f32 v[32:33], v[32:33], v[40:41]
    v_pk_add_f32 v[34:35], v[34:35], v[40:41]
    v_pk_add_f32 v[36:37], v[36:37], v[40:41]
    v_pk_add_f32 v[38:39], v[38:39], v[40:41]
    v_rcp_f32 v24, v24
    v_rcp_f32 v25, v25
    v_rcp_f32 v26, v26
    v_rcp_f32 v27, v27
    v_rcp_f32 v28, v28
    v_rcp_f32 v29, v29
    v_rcp_f32 v30, v30
    v_rcp_f32 v31, v31
    v_rcp_f32 v32, v32
    v_rcp_f32 v33, v33
    v_rcp_f32 v34, v34
    v_rcp_f32 v35, v35
    v_rcp_f32 v36, v36
    v_rcp_f32 v37, v37
    v_rcp_f32 v38, v38
    v_rcp_f32 v39, v39
    v_pk_mul_f32 v[24:25], v[24:25], v[8:9]
    v_pk_mul_f32 v[26:27], v[26:27], v[10:11]
    v_pk_mul_f32 v[28:29], v[28:29], v[12:13]
    v_pk_mul_f32 v[30:31], v[30:31], v[14:15]
    v_pk_mul_f32 v[32:33], v[32:33], v[16:17]
    v_pk_mul_f32 v[34:35], v[34:35], v[18:19]
    v_pk_mul_f32 v[36:37], v[36:37], v[20:21]
    v_pk_mul_f32 v[38:39], v[38:39], v[22:23]
    s_waitcnt vmcnt(0)
    v_lshlrev_b32 v44, 16, v176
    v_and_b32 v45, 0xffff0000, v176
    v_lshlrev_b32 v46, 16, v177
    v_and_b32 v47, 0xffff0000, v177
    v_lshlrev_b32 v48, 16, v178
    v_and_b32 v49, 0xffff0000, v178
    v_lshlrev_b32 v50, 16, v179
    v_and_b32 v51, 0xffff0000, v179
    v_lshlrev_b32 v52, 16, v180
    v_and_b32 v53, 0xffff0000, v180
    v_lshlrev_b32 v54, 16, v181
    v_and_b32 v55, 0xffff0000, v181
    v_lshlrev_b32 v56, 16, v182
    v_and_b32 v57, 0xffff0000, v182
    v_lshlrev_b32 v58, 16, v183
    v_and_b32 v59, 0xffff0000, v183
    v_pk_add_f32 v[60:61], v[44:45], v[184:185] op_sel_hi:[1,0] neg_lo:[0,1] neg_hi:[0,1]
    v_pk_add_f32 v[62:63], v[46:47], v[184:185] op_sel_hi:[1,0] neg_lo:[0,1] neg_hi:[0,1]
    v_pk_add_f32 v[64:65], v[48:49], v[184:185] op_sel_hi:[1,0] neg_lo:[0,1] neg_hi:[0,1]
    v_pk_add_f32 v[66:67], v[50:51], v[184:185] op_sel_hi:[1,0] neg_lo:[0,1] neg_hi:[0,1]
    v_pk_add_f32 v[68:69], v[52:53], v[184:185] op_sel_hi:[1,0] neg_lo:[0,1] neg_hi:[0,1]
    v_pk_add_f32 v[70:71], v[54:55], v[184:185] op_sel_hi:[1,0] neg_lo:[0,1] neg_hi:[0,1]
    v_pk_add_f32 v[72:73], v[56:57], v[184:185] op_sel_hi:[1,0] neg_lo:[0,1] neg_hi:[0,1]
    v_pk_add_f32 v[74:75], v[58:59], v[184:185] op_sel_hi:[1,0] neg_lo:[0,1] neg_hi:[0,1]
    v_pk_mul_f32 v[60:61], v[60:61], v[184:185] op_sel:[0,1] op_sel_hi:[1,1]
    v_pk_mul_f32 v[62:63], v[62:63], v[184:185] op_sel:[0,1] op_sel_hi:[1,1]
    v_pk_mul_f32 v[64:65], v[64:65], v[184:185] op_sel:[0,1] op_sel_hi:[1,1]
    v_pk_mul_f32 v[66:67], v[66:67], v[184:185] op_sel:[0,1] op_sel_hi:[1,1]
    v_pk_mul_f32 v[68:69], v[68:69], v[184:185] op_sel:[0,1] op_sel_hi:[1,1]
    v_pk_mul_f32 v[70:71], v[70:71], v[184:185] op_sel:[0,1] op_sel_hi:[1,1]
    v_pk_mul_f32 v[72:73], v[72:73], v[184:185] op_sel:[0,1] op_sel_hi:[1,1]
    v_pk_mul_f32 v[74:75], v[74:75], v[184:185] op_sel:[0,1] op_sel_hi:[1,1]
    v_lshlrev_b32 v76, 16, v112
    v_and_b32 v77, 0xffff0000, v112
    v_lshlrev_b32 v78, 16, v113
    v_and_b32 v79, 0xffff0000, v113
    v_lshlrev_b32 v80, 16, v114
    v_and_b32 v81, 0xffff0000, v114
    v_lshlrev_b32 v82, 16, v115
    v_and_b32 v83, 0xffff0000, v115
    v_lshlrev_b32 v84, 16, v116
    v_and_b32 v85, 0xffff0000, v116
    v_lshlrev_b32 v86, 16, v117
    v_and_b32 v87, 0xffff0000, v117
    v_lshlrev_b32 v88, 16, v118
    v_and_b32 v89, 0xffff0000, v118
    v_lshlrev_b32 v90, 16, v119
    v_and_b32 v91, 0xffff0000, v119
    v_pk_mul_f32 v[60:61], v[60:61], v[76:77]
    v_pk_mul_f32 v[62:63], v[62:63], v[78:79]
    v_pk_mul_f32 v[64:65], v[64:65], v[80:81]
    v_pk_mul_f32 v[66:67], v[66:67], v[82:83]
    v_pk_mul_f32 v[68:69], v[68:69], v[84:85]
    v_pk_mul_f32 v[70:71], v[70:71], v[86:87]
    v_pk_mul_f32 v[72:73], v[72:73], v[88:89]
    v_pk_mul_f32 v[74:75], v[74:75], v[90:91]
    v_pk_fma_f32 v[24:25], v[24:25], v[60:61], v[44:45]
    v_pk_fma_f32 v[26:27], v[26:27], v[62:63], v[46:47]
    v_pk_fma_f32 v[28:29], v[28:29], v[64:65], v[48:49]
    v_pk_fma_f32 v[30:31], v[30:31], v[66:67], v[50:51]
    v_pk_fma_f32 v[32:33], v[32:33], v[68:69], v[52:53]
    v_pk_fma_f32 v[34:35], v[34:35], v[70:71], v[54:55]
    v_pk_fma_f32 v[36:37], v[36:37], v[72:73], v[56:57]
    v_pk_fma_f32 v[38:39], v[38:39], v[74:75], v[58:59]
    v_cvt_pk_bf16_f32 v176, v24, v25
    v_cvt_pk_bf16_f32 v177, v26, v27
    v_cvt_pk_bf16_f32 v178, v28, v29
    v_cvt_pk_bf16_f32 v179, v30, v31
    v_cvt_pk_bf16_f32 v180, v32, v33
    v_cvt_pk_bf16_f32 v181, v34, v35
    v_cvt_pk_bf16_f32 v182, v36, v37
    v_cvt_pk_bf16_f32 v183, v38, v39
    buffer_store_dwordx4 v[176:179], v188, s[40:43], 0 offen
    buffer_store_dwordx4 v[180:183], v188, s[40:43], 0 offen offset:16
    s_branch L_bk_end_40
L_bk_loader_39:
    s_sub_u32 s52, s18, 4
    v_lshlrev_b32 v60, 4, v1
    s_lshl_b32 s53, s35, 1
    s_lshr_b32 s54, s52, 1
    s_add_u32 s53, s53, s54
    s_mul_i32 s53, s53, 112
    s_and_b32 s54, s52, 1
    s_lshl_b32 s54, s54, 2
    s_add_u32 s53, s53, s54
    s_lshl_b32 s55, s53, 10
    s_add_u32 s55, s55, 4194304
    s_lshl_b32 s57, s52, 12
    s_add_u32 s58, s57, 16384
    v_lshrrev_b32 v2, 3, v1
    v_lshlrev_b32 v2, 10, v2
    v_bfe_u32 v3, v1, 4, 1
    v_lshlrev_b32 v3, 2, v3
    v_and_b32 v4, 7, v1
    v_xor_b32 v3, v3, v4
    v_lshl_add_u32 v61, v3, 4, v2
    s_lshl_b32 s56, s52, 15
    s_lshl_b32 s53, s34, 7
    s_add_u32 s56, s56, s53
    s_mov_b32 s54, 0

    s_lshl_b32 s53, s34, 1
    s_and_b32 s59, s35, 3
    s_mul_i32 s59, s59, 3
    s_add_u32 s53, s53, s59
    s_cmp_ge_u32 s53, 14
    s_cselect_b32 s59, 14, 0
    s_sub_u32 s53, s53, s59

    s_add_u32 s36, s55, 114688
    s_mov_b32 s37, s55
    s_lshl_b32 s59, s53, 13
    s_add_u32 s55, s55, s59
    s_add_u32 s53, s53, 3
    s_cmp_ge_u32 s53, 14
    s_cselect_b32 s59, 14, 0
    s_sub_u32 s53, s53, s59
    s_lshl_b32 s53, s53, 17
    s_add_u32 s56, s56, s53

    s_waitcnt vmcnt(0)
    s_mov_b32 s54, 0
    v_mov_b32 v2, 161288
    v_mov_b32 v3, 1
    ds_add_u32 v2, v3

    s_cmp_lg_u32 s18, 4
    s_cbranch_scc1 L_ld_noactf_53
    s_cmp_eq_u32 s19, -1
    s_cbranch_scc1 L_ld_noactf_53
    s_mov_b32 s63, 0

L_ld_yspin_54:
    ds_read_b32 v3, v2
    s_add_u32 s63, s63, 1
    s_waitcnt lgkmcnt(0)
    v_readfirstlane_b32 s59, v3
    s_cmp_ge_u32 s59, 512
    s_cbranch_scc1 L_ld_ydone_55
    s_cmp_ge_u32 s63, 0x400000
    s_cbranch_scc1 L_ld_ydone_55
    s_sleep 1
    s_branch L_ld_yspin_54

L_ld_ydone_55:
    v_mov_b32 v2, s19
    v_mov_b32 v3, s62
    s_mov_b64 exec, 1
    buffer_store_dword v3, v2, s[28:31], 0 offen sc1
    s_mov_b64 exec, -1

L_ld_noactf_53:
    s_lshr_b32 s53, s35, 1
    s_lshl_b32 s53, s53, 11
    s_add_u32 s53, s53, 229376
    v_min_u32 v62, 13, v1
    v_lshl_add_u32 v62, v62, 7, s53
    v_mov_b32 v64, 161284
    s_mov_b32 s38, 0

    s_lshl_b32 s39, s34, 1
    s_and_b32 s59, s35, 3
    s_mul_i32 s59, s59, 3
    s_add_u32 s39, s39, s59
    s_cmp_ge_u32 s39, 14
    s_cselect_b32 s59, 14, 0
    s_sub_u32 s39, s39, s59

    s_cmp_gt_u32 s38, 0
    s_cbranch_scc0 L_gate_slow_57
L_gate_ok_56:
    s_add_u32 m0, s54, s57
    s_nop 0
    buffer_load_dwordx4 v60, s[28:31], s55 offen sc1 lds
    buffer_load_dwordx4 v60, s[28:31], s55 offen offset:1024 sc1 lds
    buffer_load_dwordx4 v60, s[28:31], s55 offen offset:2048 sc1 lds
    buffer_load_dwordx4 v60, s[28:31], s55 offen offset:3072 sc1 lds
    s_add_u32 s55, s55, 8192

    s_cmp_eq_u32 s55, s36
    s_cselect_b32 s55, s37, s55

    s_add_u32 s54, s54, 32768
    s_and_b32 s54, s54, 0x1ffff
    s_cmp_gt_u32 s38, 1
    s_cbranch_scc0 L_gate_slow_59
L_gate_ok_58:
    s_add_u32 m0, s54, s57
    s_nop 0
    buffer_load_dwordx4 v60, s[28:31], s55 offen sc1 lds
    buffer_load_dwordx4 v60, s[28:31], s55 offen offset:1024 sc1 lds
    buffer_load_dwordx4 v60, s[28:31], s55 offen offset:2048 sc1 lds
    buffer_load_dwordx4 v60, s[28:31], s55 offen offset:3072 sc1 lds
    s_add_u32 s55, s55, 8192

    s_cmp_eq_u32 s55, s36
    s_cselect_b32 s55, s37, s55

    s_add_u32 s54, s54, 32768
    s_and_b32 s54, s54, 0x1ffff
    s_cmp_gt_u32 s38, 2
    s_cbranch_scc0 L_gate_slow_61
L_gate_ok_60:
    s_add_u32 m0, s54, s57
    s_nop 0
    buffer_load_dwordx4 v60, s[28:31], s55 offen sc1 lds
    buffer_load_dwordx4 v60, s[28:31], s55 offen offset:1024 sc1 lds
    buffer_load_dwordx4 v60, s[28:31], s55 offen offset:2048 sc1 lds
    buffer_load_dwordx4 v60, s[28:31], s55 offen offset:3072 sc1 lds
    s_add_u32 s55, s55, 8192

    s_cmp_eq_u32 s55, s36
    s_cselect_b32 s55, s37, s55

    s_add_u32 s54, s54, 32768
    s_and_b32 s54, s54, 0x1ffff
    s_waitcnt vmcnt(8)
    s_barrier
    s_cmp_gt_u32 s38, 3
    s_cbranch_scc0 L_gate_slow_63
L_gate_ok_62:
    s_add_u32 m0, s54, s57
    s_nop 0
    buffer_load_dwordx4 v60, s[28:31], s55 offen sc1 lds
    buffer_load_dwordx4 v60, s[28:31], s55 offen offset:1024 sc1 lds
    buffer_load_dwordx4 v60, s[28:31], s55 offen offset:2048 sc1 lds
    buffer_load_dwordx4 v60, s[28:31], s55 offen offset:3072 sc1 lds
    s_add_u32 s55, s55, 8192

    s_cmp_eq_u32 s55, s36
    s_cselect_b32 s55, s37, s55

    s_add_u32 m0, s54, s58
    s_add_u32 s59, s56, 7168
    s_add_u32 s60, s56, 14336
    buffer_load_dwordx4 v61, s[24:27], s56 offen lds
    buffer_load_dwordx4 v61, s[24:27], s59 offen offset:1024 lds
    s_add_u32 s59, s56, 21504
    buffer_load_dwordx4 v61, s[24:27], s60 offen offset:2048 lds
    buffer_load_dwordx4 v61, s[24:27], s59 offen offset:3072 lds
    s_add_u32 s56, s56, 131072

    s_cmp_ge_u32 s56, 1835008
    s_cselect_b32 s59, 1835008, 0
    s_sub_u32 s56, s56, s59

    s_add_u32 s54, s54, 32768
    s_and_b32 s54, s54, 0x1ffff
    s_waitcnt vmcnt(12)
    s_barrier
    s_cmp_gt_u32 s38, 4
    s_cbranch_scc0 L_gate_slow_65
L_gate_ok_64:
    s_add_u32 m0, s54, s57
    s_nop 0
    buffer_load_dwordx4 v60, s[28:31], s55 offen sc1 lds
    buffer_load_dwordx4 v60, s[28:31], s55 offen offset:1024 sc1 lds
    buffer_load_dwordx4 v60, s[28:31], s55 offen offset:2048 sc1 lds
    buffer_load_dwordx4 v60, s[28:31], s55 offen offset:3072 sc1 lds
    s_add_u32 s55, s55, 8192

    s_cmp_eq_u32 s55, s36
    s_cselect_b32 s55, s37, s55

    s_add_u32 m0, s54, s58
    s_add_u32 s59, s56, 7168
    s_add_u32 s60, s56, 14336
    buffer_load_dwordx4 v61, s[24:27], s56 offen lds
    buffer_load_dwordx4 v61, s[24:27], s59 offen offset:1024 lds
    s_add_u32 s59, s56, 21504
    buffer_load_dwordx4 v61, s[24:27], s60 offen offset:2048 lds
    buffer_load_dwordx4 v61, s[24:27], s59 offen offset:3072 lds
    s_add_u32 s56, s56, 131072

    s_cmp_ge_u32 s56, 1835008
    s_cselect_b32 s59, 1835008, 0
    s_sub_u32 s56, s56, s59

    s_add_u32 s54, s54, 32768
    s_and_b32 s54, s54, 0x1ffff
    s_waitcnt vmcnt(16)
    s_barrier
    s_cmp_gt_u32 s38, 5
    s_cbranch_scc0 L_gate_slow_67
L_gate_ok_66:
    s_add_u32 m0, s54, s57
    s_nop 0
    buffer_load_dwordx4 v60, s[28:31], s55 offen sc1 lds
    buffer_load_dwordx4 v60, s[28:31], s55 offen offset:1024 sc1 lds
    buffer_load_dwordx4 v60, s[28:31], s55 offen offset:2048 sc1 lds
    buffer_load_dwordx4 v60, s[28:31], s55 offen offset:3072 sc1 lds
    s_add_u32 s55, s55, 8192

    s_cmp_eq_u32 s55, s36
    s_cselect_b32 s55, s37, s55

    s_add_u32 m0, s54, s58
    s_add_u32 s59, s56, 7168
    s_add_u32 s60, s56, 14336
    buffer_load_dwordx4 v61, s[24:27], s56 offen lds
    buffer_load_dwordx4 v61, s[24:27], s59 offen offset:1024 lds
    s_add_u32 s59, s56, 21504
    buffer_load_dwordx4 v61, s[24:27], s60 offen offset:2048 lds
    buffer_load_dwordx4 v61, s[24:27], s59 offen offset:3072 lds
    s_add_u32 s56, s56, 131072

    s_cmp_ge_u32 s56, 1835008
    s_cselect_b32 s59, 1835008, 0
    s_sub_u32 s56, s56, s59

    s_add_u32 s54, s54, 32768
    s_and_b32 s54, s54, 0x1ffff
    s_cmp_lg_u32 s18, 4
    s_cbranch_scc1 L_ld_nosig_68
    s_lshl_b32 s53, s2, 7
    s_add_u32 s53, s53, 262144
    v_mov_b32 v2, s53
    v_mov_b32 v3, s62
    s_mov_b64 exec, 1
    buffer_store_dword v3, v2, s[28:31], 0 offen sc1
    s_mov_b64 exec, -1

L_ld_nosig_68:
    s_mov_b32 s61, 6
L_ld_loop_69:
    s_waitcnt vmcnt(16)
    s_barrier
    s_cmp_gt_u32 s38, s61
    s_cbranch_scc0 L_gate_slow_71
L_gate_ok_70:
    s_add_u32 m0, s54, s57
    s_nop 0
    buffer_load_dwordx4 v60, s[28:31], s55 offen sc1 lds
    buffer_load_dwordx4 v60, s[28:31], s55 offen offset:1024 sc1 lds
    buffer_load_dwordx4 v60, s[28:31], s55 offen offset:2048 sc1 lds
    buffer_load_dwordx4 v60, s[28:31], s55 offen offset:3072 sc1 lds
    s_add_u32 s55, s55, 8192

    s_cmp_eq_u32 s55, s36
    s_cselect_b32 s55, s37, s55

    s_add_u32 m0, s54, s58
    s_add_u32 s59, s56, 7168
    s_add_u32 s60, s56, 14336
    buffer_load_dwordx4 v61, s[24:27], s56 offen lds
    buffer_load_dwordx4 v61, s[24:27], s59 offen offset:1024 lds
    s_add_u32 s59, s56, 21504
    buffer_load_dwordx4 v61, s[24:27], s60 offen offset:2048 lds
    buffer_load_dwordx4 v61, s[24:27], s59 offen offset:3072 lds
    s_add_u32 s56, s56, 131072

    s_cmp_ge_u32 s56, 1835008
    s_cselect_b32 s59, 1835008, 0
    s_sub_u32 s56, s56, s59

    s_add_u32 s54, s54, 32768
    s_and_b32 s54, s54, 0x1ffff
    s_add_u32 s61, s61, 1
    s_cmp_lt_u32 s61, 14
    s_cbranch_scc1 L_ld_loop_69

    s_waitcnt vmcnt(16)
    s_barrier
    s_waitcnt vmcnt(8)
    s_barrier
    s_waitcnt vmcnt(0)
    s_barrier
    s_branch L_ldg_end_72
L_gate_slow_57:
    s_mov_b32 s63, 0
    s_cmp_lg_u32 s18, 4
    s_cbranch_scc1 L_gate_oth_300059

L_gate_spin_300058:
    buffer_load_dword v63, v62, s[28:31], 0 offen sc1
    s_add_u32 s63, s63, 1
    s_waitcnt vmcnt(0)
    v_cmp_eq_u32 vcc, s62, v63
    s_sub_u32 s59, 14, s39
    s_nop 0
    s_and_b32 s60, vcc_lo, 0x3fff
    s_lshl_b32 s59, s60, s59
    s_lshr_b32 s60, s60, s39
    s_or_b32 s60, s60, s59
    s_and_b32 s60, s60, 0x3fff
    s_ff0_i32_b32 s38, s60
    v_mov_b32 v63, s38
    ds_write_b32 v64, v63
    s_cmp_gt_u32 s38, 0
    s_cbranch_scc1 L_gate_ok_56
    s_cmp_ge_u32 s63, 0x40000
    s_cbranch_scc1 L_gate_ok_56
    s_sleep 2
    s_branch L_gate_spin_300058

L_gate_oth_300059:
L_gate_ospin_300060:
    ds_read_b32 v63, v64
    s_add_u32 s63, s63, 1
    s_waitcnt lgkmcnt(0)
    v_readfirstlane_b32 s38, v63
    s_cmp_gt_u32 s38, 0
    s_cbranch_scc1 L_gate_ok_56
    s_cmp_ge_u32 s63, 0x400000
    s_cbranch_scc1 L_gate_ok_56
    s_sleep 1
    s_branch L_gate_ospin_300060

L_gate_slow_59:
    s_mov_b32 s63, 0
    s_cmp_lg_u32 s18, 4
    s_cbranch_scc1 L_gate_oth_301061

L_gate_spin_301060:
    buffer_load_dword v63, v62, s[28:31], 0 offen sc1
    s_add_u32 s63, s63, 1
    s_waitcnt vmcnt(0)
    v_cmp_eq_u32 vcc, s62, v63
    s_sub_u32 s59, 14, s39
    s_nop 0
    s_and_b32 s60, vcc_lo, 0x3fff
    s_lshl_b32 s59, s60, s59
    s_lshr_b32 s60, s60, s39
    s_or_b32 s60, s60, s59
    s_and_b32 s60, s60, 0x3fff
    s_ff0_i32_b32 s38, s60
    v_mov_b32 v63, s38
    ds_write_b32 v64, v63
    s_cmp_gt_u32 s38, 1
    s_cbranch_scc1 L_gate_ok_58
    s_cmp_ge_u32 s63, 0x40000
    s_cbranch_scc1 L_gate_ok_58
    s_sleep 2
    s_branch L_gate_spin_301060

L_gate_oth_301061:
L_gate_ospin_301062:
    ds_read_b32 v63, v64
    s_add_u32 s63, s63, 1
    s_waitcnt lgkmcnt(0)
    v_readfirstlane_b32 s38, v63
    s_cmp_gt_u32 s38, 1
    s_cbranch_scc1 L_gate_ok_58
    s_cmp_ge_u32 s63, 0x400000
    s_cbranch_scc1 L_gate_ok_58
    s_sleep 1
    s_branch L_gate_ospin_301062

L_gate_slow_61:
    s_mov_b32 s63, 0
    s_cmp_lg_u32 s18, 4
    s_cbranch_scc1 L_gate_oth_302063

L_gate_spin_302062:
    buffer_load_dword v63, v62, s[28:31], 0 offen sc1
    s_add_u32 s63, s63, 1
    s_waitcnt vmcnt(0)
    v_cmp_eq_u32 vcc, s62, v63
    s_sub_u32 s59, 14, s39
    s_nop 0
    s_and_b32 s60, vcc_lo, 0x3fff
    s_lshl_b32 s59, s60, s59
    s_lshr_b32 s60, s60, s39
    s_or_b32 s60, s60, s59
    s_and_b32 s60, s60, 0x3fff
    s_ff0_i32_b32 s38, s60
    v_mov_b32 v63, s38
    ds_write_b32 v64, v63
    s_cmp_gt_u32 s38, 2
    s_cbranch_scc1 L_gate_ok_60
    s_cmp_ge_u32 s63, 0x40000
    s_cbranch_scc1 L_gate_ok_60
    s_sleep 2
    s_branch L_gate_spin_302062

L_gate_oth_302063:
L_gate_ospin_302064:
    ds_read_b32 v63, v64
    s_add_u32 s63, s63, 1
    s_waitcnt lgkmcnt(0)
    v_readfirstlane_b32 s38, v63
    s_cmp_gt_u32 s38, 2
    s_cbranch_scc1 L_gate_ok_60
    s_cmp_ge_u32 s63, 0x400000
    s_cbranch_scc1 L_gate_ok_60
    s_sleep 1
    s_branch L_gate_ospin_302064

L_gate_slow_63:
    s_mov_b32 s63, 0
    s_cmp_lg_u32 s18, 4
    s_cbranch_scc1 L_gate_oth_303065

L_gate_spin_303064:
    buffer_load_dword v63, v62, s[28:31], 0 offen sc1
    s_add_u32 s63, s63, 1
    s_waitcnt vmcnt(0)
    v_cmp_eq_u32 vcc, s62, v63
    s_sub_u32 s59, 14, s39
    s_nop 0
    s_and_b32 s60, vcc_lo, 0x3fff
    s_lshl_b32 s59, s60, s59
    s_lshr_b32 s60, s60, s39
    s_or_b32 s60, s60, s59
    s_and_b32 s60, s60, 0x3fff
    s_ff0_i32_b32 s38, s60
    v_mov_b32 v63, s38
    ds_write_b32 v64, v63
    s_cmp_gt_u32 s38, 3
    s_cbranch_scc1 L_gate_ok_62
    s_cmp_ge_u32 s63, 0x40000
    s_cbranch_scc1 L_gate_ok_62
    s_sleep 2
    s_branch L_gate_spin_303064

L_gate_oth_303065:
L_gate_ospin_303066:
    ds_read_b32 v63, v64
    s_add_u32 s63, s63, 1
    s_waitcnt lgkmcnt(0)
    v_readfirstlane_b32 s38, v63
    s_cmp_gt_u32 s38, 3
    s_cbranch_scc1 L_gate_ok_62
    s_cmp_ge_u32 s63, 0x400000
    s_cbranch_scc1 L_gate_ok_62
    s_sleep 1
    s_branch L_gate_ospin_303066

L_gate_slow_65:
    s_mov_b32 s63, 0
    s_cmp_lg_u32 s18, 4
    s_cbranch_scc1 L_gate_oth_304067

L_gate_spin_304066:
    buffer_load_dword v63, v62, s[28:31], 0 offen sc1
    s_add_u32 s63, s63, 1
    s_waitcnt vmcnt(0)
    v_cmp_eq_u32 vcc, s62, v63
    s_sub_u32 s59, 14, s39
    s_nop 0
    s_and_b32 s60, vcc_lo, 0x3fff
    s_lshl_b32 s59, s60, s59
    s_lshr_b32 s60, s60, s39
    s_or_b32 s60, s60, s59
    s_and_b32 s60, s60, 0x3fff
    s_ff0_i32_b32 s38, s60
    v_mov_b32 v63, s38
    ds_write_b32 v64, v63
    s_cmp_gt_u32 s38, 4
    s_cbranch_scc1 L_gate_ok_64
    s_cmp_ge_u32 s63, 0x40000
    s_cbranch_scc1 L_gate_ok_64
    s_sleep 2
    s_branch L_gate_spin_304066

L_gate_oth_304067:
L_gate_ospin_304068:
    ds_read_b32 v63, v64
    s_add_u32 s63, s63, 1
    s_waitcnt lgkmcnt(0)
    v_readfirstlane_b32 s38, v63
    s_cmp_gt_u32 s38, 4
    s_cbranch_scc1 L_gate_ok_64
    s_cmp_ge_u32 s63, 0x400000
    s_cbranch_scc1 L_gate_ok_64
    s_sleep 1
    s_branch L_gate_ospin_304068

L_gate_slow_67:
    s_mov_b32 s63, 0
    s_cmp_lg_u32 s18, 4
    s_cbranch_scc1 L_gate_oth_305069

L_gate_spin_305068:
    buffer_load_dword v63, v62, s[28:31], 0 offen sc1
    s_add_u32 s63, s63, 1
    s_waitcnt vmcnt(0)
    v_cmp_eq_u32 vcc, s62, v63
    s_sub_u32 s59, 14, s39
    s_nop 0
    s_and_b32 s60, vcc_lo, 0x3fff
    s_lshl_b32 s59, s60, s59
    s_lshr_b32 s60, s60, s39
    s_or_b32 s60, s60, s59
    s_and_b32 s60, s60, 0x3fff
    s_ff0_i32_b32 s38, s60
    v_mov_b32 v63, s38
    ds_write_b32 v64, v63
    s_cmp_gt_u32 s38, 5
    s_cbranch_scc1 L_gate_ok_66
    s_cmp_ge_u32 s63, 0x40000
    s_cbranch_scc1 L_gate_ok_66
    s_sleep 2
    s_branch L_gate_spin_305068

L_gate_oth_305069:
L_gate_ospin_305070:
    ds_read_b32 v63, v64
    s_add_u32 s63, s63, 1
    s_waitcnt lgkmcnt(0)
    v_readfirstlane_b32 s38, v63
    s_cmp_gt_u32 s38, 5
    s_cbranch_scc1 L_gate_ok_66
    s_cmp_ge_u32 s63, 0x400000
    s_cbranch_scc1 L_gate_ok_66
    s_sleep 1
    s_branch L_gate_ospin_305070

L_gate_slow_71:
    s_mov_b32 s63, 0
    s_cmp_lg_u32 s18, 4
    s_cbranch_scc1 L_gate_oth_306073

L_gate_spin_306072:
    buffer_load_dword v63, v62, s[28:31], 0 offen sc1
    s_add_u32 s63, s63, 1
    s_waitcnt vmcnt(0)
    v_cmp_eq_u32 vcc, s62, v63
    s_sub_u32 s59, 14, s39
    s_nop 0
    s_and_b32 s60, vcc_lo, 0x3fff
    s_lshl_b32 s59, s60, s59
    s_lshr_b32 s60, s60, s39
    s_or_b32 s60, s60, s59
    s_and_b32 s60, s60, 0x3fff
    s_ff0_i32_b32 s38, s60
    v_mov_b32 v63, s38
    ds_write_b32 v64, v63
    s_cmp_gt_u32 s38, s61
    s_cbranch_scc1 L_gate_ok_70
    s_cmp_ge_u32 s63, 0x40000
    s_cbranch_scc1 L_gate_ok_70
    s_sleep 2
    s_branch L_gate_spin_306072

L_gate_oth_306073:
L_gate_ospin_306074:
    ds_read_b32 v63, v64
    s_add_u32 s63, s63, 1
    s_waitcnt lgkmcnt(0)
    v_readfirstlane_b32 s38, v63
    s_cmp_gt_u32 s38, s61
    s_cbranch_scc1 L_gate_ok_70
    s_cmp_ge_u32 s63, 0x400000
    s_cbranch_scc1 L_gate_ok_70
    s_sleep 1
    s_branch L_gate_ospin_306074

L_ldg_end_72:
L_bk_end_40:
L_all_end:
    s_endpgm
L_code_end:
.section .rodata,"a"
.p2align 6
.amdhsa_kernel recurrent_scan__ssm_conv_h3__dense_activation_mish__prompt_kernel
  .amdhsa_next_free_vgpr 200
  .amdhsa_next_free_sgpr 64
  .amdhsa_accum_offset 200
  .amdhsa_group_segment_fixed_size 0
  .amdhsa_kernarg_size 104
  .amdhsa_user_sgpr_count 2
  .amdhsa_user_sgpr_kernarg_segment_ptr 1
  .amdhsa_system_sgpr_workgroup_id_x 1
  .amdhsa_float_denorm_mode_32 3
.end_amdhsa_kernel
```
